```python
import torch

def _softmax(x, axis=-1):
    return torch.softmax(x, dim=axis)
def _gelu(x):
    return torch.nn.functional.gelu(x, approximate="tanh")
def _silu(x):
    return torch.nn.functional.silu(x)
def _sigmoid(x):
    return torch.sigmoid(x)
def _layernorm(x, axis=-1, eps=1e-5):
    m = x.mean(dim=axis, keepdim=True)
    v = x.var(dim=axis, keepdim=True, unbiased=False)
    return (x - m) / torch.sqrt(v + eps)
def _scatter_add(tgt, idx, src, axis=0):
    return tgt.clone().index_add_(axis, idx, src)
def _segment_sum(src, seg, n):
    out = torch.zeros((n,) + src.shape[1:], dtype=src.dtype)
    return out.index_add_(0, seg, src)
def _pad(x, pw):
    flat = tuple(v for pair in reversed(pw) for v in pair)
    return torch.nn.functional.pad(x, flat)

kernel_name = 'recurrent_scan__sliding_block_cached__swiglu_ffn__decode'

def setup_inputs():

    _w = (lambda a: (lambda t: t.to(torch.bfloat16) if t.is_floating_point() else t)(torch.as_tensor(a)))
    def _A_setup():
        B, Sq, D = 1, 1, 576
        Hq, Hkv, Sk, Dh = 32, 16, 65536, 128
        assert Hq % Hkv == 0, (Hq, Hkv)
        return {
            "x": _w((lambda *s: torch.randn(*s, dtype=torch.bfloat16) * 0.05)(B, Sq, D)),
            "k_cache": _w((lambda *s: torch.randn(*s, dtype=torch.bfloat16) * 0.8)(B, Hkv, Sk, Dh)),
            "v_cache": _w((lambda *s: torch.randn(*s, dtype=torch.bfloat16) * 0.2)(B, Hkv, Sk, Dh)),
            "wq": _w((lambda *s: torch.randn(*s, dtype=torch.bfloat16) * 0.8)(D, Hq * Dh) * (D ** -0.5)),
            "wo": _w((lambda *s: torch.randn(*s, dtype=torch.bfloat16) * 0.2)(Hq * Dh, D) * ((Hq * Dh) ** -0.5)),
        }
    _A_in = _A_setup()

    def _B_setup():
        B, S, D, F = 1, 1, 576, 4608
        return {
            "x": _w((lambda *s: torch.randn(*s, dtype=torch.bfloat16) * 0.05)(B, S, D)),
            "w_gate": _w((lambda *s: torch.randn(*s, dtype=torch.bfloat16) * 0.1)(D, F)),
            "w_up": _w((lambda *s: torch.randn(*s, dtype=torch.bfloat16) * 0.1)(D, F)),
            "w_down": _w((lambda *s: torch.randn(*s, dtype=torch.bfloat16) * 0.1)(F, D)),
        }
    _B_in = _B_setup()

    return {
        "A_x": _A_in["x"],
        "A_k_cache": _A_in["k_cache"],
        "A_v_cache": _A_in["v_cache"],
        "A_wq": _A_in["wq"],
        "A_wo": _A_in["wo"],
        "B_x": _B_in["x"],
        "B_w_gate": _B_in["w_gate"],
        "B_w_up": _B_in["w_up"],
        "B_w_down": _B_in["w_down"],
    }

def reference(A_x, A_k_cache, A_v_cache, A_wq, A_wo, B_x, B_w_gate, B_w_up, B_w_down):
    def _A_ref(x, k_cache, v_cache, wq, wo):
        B, Sq, D = x.shape
        Hq, Dh = 32, 128
        Hkv, Sk = k_cache.shape[1], k_cache.shape[2]
        W = min(4096, max(256, Sk // 4))
        rep = Hq // Hkv
        q = (lambda x, *d: x.permute(*d))((x @ wq).reshape(B, Sq, Hq, Dh), 0, 2, 1, 3)
        k = (lambda x, n, axis: torch.repeat_interleave(x, n, dim=axis))(k_cache[:, :, Sk - W:, :], rep, axis=1)
        v = (lambda x, n, axis: torch.repeat_interleave(x, n, dim=axis))(v_cache[:, :, Sk - W:, :], rep, axis=1)
        scores = torch.einsum("bhqd,bhkd->bhqk", q, k) * (Dh ** -0.5)
        p = _softmax(scores, axis=-1)
        o = torch.einsum("bhqk,bhkd->bhqd", p, v)
        return (lambda x, *d: x.permute(*d))(o, 0, 2, 1, 3).reshape(B, Sq, Hq * Dh) @ wo

    def _B_ref(x, w_gate, w_up, w_down):
        g = _silu(x @ w_gate)
        u = x @ w_up
        return (g * u) @ w_down

    x = A_x
    xn = _layernorm(x, axis=-1)
    s = _A_ref(xn, A_k_cache, A_v_cache, A_wq, A_wo)
    g = _silu(_B_ref(xn, B_w_gate, B_w_up, B_w_down))
    return x + s * g
```

```asm
; @launch grid=(256,1,1) block=(1024,1,1) lds=30208
.amdgcn_target "amdgcn-amd-amdhsa--gfx950"
.text
.globl recurrent_scan__sliding_block_cached__swiglu_ffn__decode_kernel
.p2align 8
.type recurrent_scan__sliding_block_cached__swiglu_ffn__decode_kernel,@function
recurrent_scan__sliding_block_cached__swiglu_ffn__decode_kernel:
s_cmp_ge_u32 s2, 256
s_cbranch_scc1 L_end
s_load_dwordx16 s[4:19], s[0:1], 0
s_load_dwordx8 s[20:27], s[0:1], 64
v_and_b32 v1, 63, v0
v_lshrrev_b32 v2, 6, v0
s_and_b32 s90, s2, 7
v_readfirstlane_b32 s3, v2
s_lshr_b32 s91, s2, 3
s_lshl_b32 s92, s90, 1
s_lshr_b32 s72, s91, 4
s_add_u32 s92, s92, s72
s_and_b32 s93, s91, 15
s_cmp_lt_u32 s90, 4
s_cselect_b32 s38, 20, 16
s_mul_i32 s72, s90, 20
s_mul_i32 s73, s90, 16
s_add_u32 s73, s73, 16
s_cmp_lt_u32 s90, 4
s_cselect_b32 s39, s72, s73
s_mov_b32 s36, 0
s_mov_b32 s37, s91
s_cmp_lt_u32 s91, s38
s_cbranch_scc1 L_typed
s_mov_b32 s36, 1
s_sub_u32 s37, s91, s38
s_cmp_lt_u32 s37, 8
s_cbranch_scc1 L_typed
s_mov_b32 s36, 2
s_sub_u32 s37, s37, 8
L_typed:
s_mov_b32 s100, 32768
s_getreg_b32 s101, hwreg(HW_REG_XCC_ID)
s_and_b32 s101, s101, 15
v_and_b32 v2, 1, v1
v_mov_b32 v3, 0xffff
v_lshlrev_b32 v2, 4, v2
v_lshlrev_b32 v3, v2, v3
v_bfe_u32 v2, v1, 1, 2
v_cmp_eq_u32 vcc, 0, v2
s_nop 1
v_cndmask_b32 v124, 0, v3, vcc
v_cmp_eq_u32 vcc, 1, v2
s_nop 1
v_cndmask_b32 v125, 0, v3, vcc
v_cmp_eq_u32 vcc, 2, v2
s_nop 1
v_cndmask_b32 v126, 0, v3, vcc
v_cmp_eq_u32 vcc, 3, v2
s_nop 1
v_cndmask_b32 v127, 0, v3, vcc
s_waitcnt lgkmcnt(0)
s_load_dword s94, s[26:27], 0
s_mov_b32 s96, s26
s_mov_b32 s97, s27
s_mov_b32 s98, 1073741824
s_mov_b32 s99, 0x20000
s_cmp_lt_u32 s3, 4
s_cbranch_scc1 L_aux0
s_cmp_lt_u32 s3, 12
s_cbranch_scc1 L_KV
s_sub_u32 s95, s3, 8
s_branch L_aux
L_aux0:
s_mov_b32 s95, s3
L_aux:
s_setprio 2
s_cmp_ge_u32 s95, 6
s_cbranch_scc1 L_aux67
s_cmp_eq_u32 s36, 2
s_cbranch_scc1 L_auxO
s_mov_b32 s32, s4
s_mov_b32 s33, s5
s_mov_b32 s34, 1152
s_mov_b32 s35, 0x20000
v_lshlrev_b32 v5, 4, v1
buffer_load_dwordx4 v[56:59], v5, s[32:35], 0 offen
buffer_load_dwordx4 v[60:63], v5, s[32:35], 0 offen offset:1024
v_lshrrev_b32 v64, 4, v1
v_and_b32 v65, 15, v1
v_lshlrev_b32 v65, 4, v65
s_cmp_eq_u32 s36, 1
s_cbranch_scc1 L_auxQ
s_add_u32 s72, s39, s91
s_lshr_b32 s88, s72, 2
s_and_b32 s89, s72, 3
s_cmp_ge_u32 s95, 3
s_cselect_b32 s73, 3, 0
s_sub_u32 s73, s95, s73
s_mul_i32 s87, s89, 144
s_mul_i32 s73, s73, 48
s_add_u32 s87, s87, s73
s_cmp_lt_u32 s95, 3
s_cselect_b32 s28, s16, s18
s_cselect_b32 s29, s17, s19
s_mov_b32 s30, 5308416
s_mov_b32 s31, 0x20000
s_mul_i32 s72, s87, 9216
s_lshl_b32 s73, s88, 8
s_add_u32 s72, s72, s73
v_mul_u32_u24 v5, 9216, v64
v_add_u32 v5, v5, v65
v_add_u32 v5, s72, v5
s_mov_b32 s76, 36864
s_branch L_p1loadF
L_auxQ:
s_lshl_b32 s72, s90, 3
s_add_u32 s72, s72, s37
s_lshr_b32 s88, s72, 1
s_and_b32 s89, s72, 1
s_mul_i32 s87, s89, 288
s_mul_i32 s72, s95, 48
s_add_u32 s87, s87, s72
s_mov_b32 s28, s10
s_mov_b32 s29, s11
s_mov_b32 s30, 4718592
s_mov_b32 s31, 0x20000
s_lshl_b32 s72, s87, 13
s_lshl_b32 s73, s88, 8
s_add_u32 s72, s72, s73
v_lshlrev_b32 v5, 13, v64
v_add_u32 v5, v5, v65
v_add_u32 v5, s72, v5
s_mov_b32 s76, 32768
L_p1load:
s_mov_b32 s77, 0
buffer_load_dwordx4 v[8:11], v5, s[28:31], s77 offen nt
s_add_u32 s77, s77, s76
buffer_load_dwordx4 v[12:15], v5, s[28:31], s77 offen nt
s_add_u32 s77, s77, s76
buffer_load_dwordx4 v[16:19], v5, s[28:31], s77 offen nt
s_add_u32 s77, s77, s76
s_waitcnt lgkmcnt(0)
s_mul_i32 s94, s94, 1664525
s_add_u32 s94, s94, 1013904223
s_barrier
buffer_load_dwordx4 v[20:23], v5, s[28:31], s77 offen nt
s_add_u32 s77, s77, s76
buffer_load_dwordx4 v[24:27], v5, s[28:31], s77 offen nt
s_add_u32 s77, s77, s76
buffer_load_dwordx4 v[28:31], v5, s[28:31], s77 offen nt
s_add_u32 s77, s77, s76
buffer_load_dwordx4 v[32:35], v5, s[28:31], s77 offen nt
s_add_u32 s77, s77, s76
buffer_load_dwordx4 v[36:39], v5, s[28:31], s77 offen nt
s_add_u32 s77, s77, s76
buffer_load_dwordx4 v[40:43], v5, s[28:31], s77 offen nt
s_add_u32 s77, s77, s76
buffer_load_dwordx4 v[44:47], v5, s[28:31], s77 offen nt
s_add_u32 s77, s77, s76
buffer_load_dwordx4 v[48:51], v5, s[28:31], s77 offen nt
s_add_u32 s77, s77, s76
buffer_load_dwordx4 v[52:55], v5, s[28:31], s77 offen nt
s_branch L_p1ld_e
L_p1loadF:
s_mov_b32 s77, 0
buffer_load_dwordx4 v[8:11], v5, s[28:31], s77 offen nt
s_add_u32 s77, s77, s76
buffer_load_dwordx4 v[12:15], v5, s[28:31], s77 offen nt
s_add_u32 s77, s77, s76
buffer_load_dwordx4 v[16:19], v5, s[28:31], s77 offen nt
s_add_u32 s77, s77, s76
s_waitcnt lgkmcnt(0)
s_mul_i32 s94, s94, 1664525
s_add_u32 s94, s94, 1013904223
s_barrier
buffer_load_dwordx4 v[20:23], v5, s[28:31], s77 offen nt
s_add_u32 s77, s77, s76
buffer_load_dwordx4 v[24:27], v5, s[28:31], s77 offen nt
s_add_u32 s77, s77, s76
s_waitcnt vmcnt(4)
buffer_load_dwordx4 v[28:31], v5, s[28:31], s77 offen nt
s_add_u32 s77, s77, s76
s_waitcnt vmcnt(4)
buffer_load_dwordx4 v[32:35], v5, s[28:31], s77 offen nt
s_add_u32 s77, s77, s76
s_waitcnt vmcnt(4)
buffer_load_dwordx4 v[36:39], v5, s[28:31], s77 offen nt
s_add_u32 s77, s77, s76
s_waitcnt vmcnt(4)
buffer_load_dwordx4 v[40:43], v5, s[28:31], s77 offen nt
s_add_u32 s77, s77, s76
s_waitcnt vmcnt(4)
buffer_load_dwordx4 v[44:47], v5, s[28:31], s77 offen nt
s_add_u32 s77, s77, s76
s_waitcnt vmcnt(4)
buffer_load_dwordx4 v[48:51], v5, s[28:31], s77 offen nt
s_add_u32 s77, s77, s76
s_waitcnt vmcnt(4)
buffer_load_dwordx4 v[52:55], v5, s[28:31], s77 offen nt
L_p1ld_e:
v_mov_b32 v7, 0
v_mov_b32 v6, 1
s_waitcnt lgkmcnt(0)
s_mov_b64 s[74:75], exec
s_mov_b64 exec, 1
ds_add_u32 v7, v6 offset:36
s_mov_b64 exec, s[74:75]
s_waitcnt vmcnt(12)
v_lshlrev_b32 v5, 4, v1
ds_write_b128 v5, v[56:59] offset:64
s_mov_b64 exec, 0xff
ds_write_b128 v5, v[60:63] offset:1088
s_mov_b64 exec, -1
v_mov_b32 v64, 0
v_mov_b32 v65, 0
v_mov_b32 v66, 0x3f803f80
v_dot2c_f32_bf16 v64, v56, v66
v_dot2c_f32_bf16 v65, v56, v56
v_dot2c_f32_bf16 v64, v57, v66
v_dot2c_f32_bf16 v65, v57, v57
v_dot2c_f32_bf16 v64, v58, v66
v_dot2c_f32_bf16 v65, v58, v58
v_dot2c_f32_bf16 v64, v59, v66
v_dot2c_f32_bf16 v65, v59, v59
v_dot2c_f32_bf16 v64, v60, v66
v_dot2c_f32_bf16 v65, v60, v60
v_dot2c_f32_bf16 v64, v61, v66
v_dot2c_f32_bf16 v65, v61, v61
v_dot2c_f32_bf16 v64, v62, v66
v_dot2c_f32_bf16 v65, v62, v62
v_dot2c_f32_bf16 v64, v63, v66
v_dot2c_f32_bf16 v65, v63, v63
s_lshl_b32 s72, s87, 1
v_lshrrev_b32 v5, 4, v1
v_lshlrev_b32 v5, 1, v5
v_add_u32 v5, s72, v5
s_waitcnt lgkmcnt(0)
ds_read_u16 v68, v5 offset:64
ds_read_u16 v69, v5 offset:72
ds_read_u16 v70, v5 offset:80
ds_read_u16 v71, v5 offset:88
ds_read_u16 v72, v5 offset:96
ds_read_u16 v73, v5 offset:104
ds_read_u16 v74, v5 offset:112
ds_read_u16 v75, v5 offset:120
ds_read_u16 v76, v5 offset:128
ds_read_u16 v77, v5 offset:136
ds_read_u16 v78, v5 offset:144
ds_read_u16 v79, v5 offset:152
s_nop 0
v_add_f32_dpp v64, v64, v64 quad_perm:[1,0,3,2] row_mask:0xf bank_mask:0xf
v_add_f32_dpp v65, v65, v65 quad_perm:[1,0,3,2] row_mask:0xf bank_mask:0xf
s_nop 0
v_add_f32_dpp v64, v64, v64 quad_perm:[2,3,0,1] row_mask:0xf bank_mask:0xf
v_add_f32_dpp v65, v65, v65 quad_perm:[2,3,0,1] row_mask:0xf bank_mask:0xf
s_nop 0
v_add_f32_dpp v64, v64, v64 row_half_mirror row_mask:0xf bank_mask:0xf
v_add_f32_dpp v65, v65, v65 row_half_mirror row_mask:0xf bank_mask:0xf
s_nop 0
v_add_f32_dpp v64, v64, v64 row_mirror row_mask:0xf bank_mask:0xf
v_add_f32_dpp v65, v65, v65 row_mirror row_mask:0xf bank_mask:0xf
v_mov_b32 v66, v64
v_mov_b32 v67, v65
s_nop 0
v_permlane16_swap_b32 v64, v66
v_permlane16_swap_b32 v65, v67
s_nop 0
v_add_f32 v64, v64, v66
v_add_f32 v65, v65, v67
v_mov_b32 v66, v64
v_mov_b32 v67, v65
s_nop 0
v_permlane32_swap_b32 v64, v66
v_permlane32_swap_b32 v65, v67
s_nop 0
v_add_f32 v64, v64, v66
v_add_f32 v65, v65, v67
s_mov_b32 s72, 0x3ae38e39
v_mul_f32 v64, s72, v64
v_mul_f32 v65, s72, v65
v_fma_f32 v65, -v64, v64, v65
v_max_f32 v65, 0, v65
v_cvt_pk_bf16_f32 v64, v64, v64
v_and_b32 v64, 0xffff0000, v64
v_cvt_pk_bf16_f32 v65, v65, v65
v_and_b32 v65, 0xffff0000, v65
v_add_f32 v65, 0x3727c5ac, v65
v_cvt_pk_bf16_f32 v65, v65, v65
v_and_b32 v65, 0xffff0000, v65
v_sqrt_f32 v65, v65
s_nop 0
v_cvt_pk_bf16_f32 v65, v65, v65
v_and_b32 v65, 0xffff0000, v65
v_rcp_f32 v65, v65
s_waitcnt lgkmcnt(0)
v_lshlrev_b32 v68, 16, v68
v_lshlrev_b32 v69, 16, v69
v_lshlrev_b32 v70, 16, v70
v_lshlrev_b32 v71, 16, v71
v_lshlrev_b32 v72, 16, v72
v_lshlrev_b32 v73, 16, v73
v_lshlrev_b32 v74, 16, v74
v_lshlrev_b32 v75, 16, v75
v_lshlrev_b32 v76, 16, v76
v_lshlrev_b32 v77, 16, v77
v_lshlrev_b32 v78, 16, v78
v_lshlrev_b32 v79, 16, v79
v_sub_f32 v68, v68, v64
v_sub_f32 v69, v69, v64
v_sub_f32 v70, v70, v64
v_sub_f32 v71, v71, v64
v_sub_f32 v72, v72, v64
v_sub_f32 v73, v73, v64
v_sub_f32 v74, v74, v64
v_sub_f32 v75, v75, v64
v_sub_f32 v76, v76, v64
v_sub_f32 v77, v77, v64
v_sub_f32 v78, v78, v64
v_sub_f32 v79, v79, v64
v_cvt_pk_bf16_f32 v68, v68, v68
v_cvt_pk_bf16_f32 v69, v69, v69
v_cvt_pk_bf16_f32 v70, v70, v70
v_cvt_pk_bf16_f32 v71, v71, v71
v_cvt_pk_bf16_f32 v72, v72, v72
v_cvt_pk_bf16_f32 v73, v73, v73
v_cvt_pk_bf16_f32 v74, v74, v74
v_cvt_pk_bf16_f32 v75, v75, v75
v_cvt_pk_bf16_f32 v76, v76, v76
v_cvt_pk_bf16_f32 v77, v77, v77
v_cvt_pk_bf16_f32 v78, v78, v78
v_cvt_pk_bf16_f32 v79, v79, v79
v_and_b32 v68, 0xffff0000, v68
v_and_b32 v69, 0xffff0000, v69
v_and_b32 v70, 0xffff0000, v70
v_and_b32 v71, 0xffff0000, v71
v_and_b32 v72, 0xffff0000, v72
v_and_b32 v73, 0xffff0000, v73
v_and_b32 v74, 0xffff0000, v74
v_and_b32 v75, 0xffff0000, v75
v_and_b32 v76, 0xffff0000, v76
v_and_b32 v77, 0xffff0000, v77
v_and_b32 v78, 0xffff0000, v78
v_and_b32 v79, 0xffff0000, v79
v_mul_f32 v68, v68, v65
v_mul_f32 v69, v69, v65
v_mul_f32 v70, v70, v65
v_mul_f32 v71, v71, v65
v_mul_f32 v72, v72, v65
v_mul_f32 v73, v73, v65
v_mul_f32 v74, v74, v65
v_mul_f32 v75, v75, v65
v_mul_f32 v76, v76, v65
v_mul_f32 v77, v77, v65
v_mul_f32 v78, v78, v65
v_mul_f32 v79, v79, v65
v_cvt_pk_bf16_f32 v68, v68, v68
v_cvt_pk_bf16_f32 v69, v69, v69
v_cvt_pk_bf16_f32 v70, v70, v70
v_cvt_pk_bf16_f32 v71, v71, v71
v_cvt_pk_bf16_f32 v72, v72, v72
v_cvt_pk_bf16_f32 v73, v73, v73
v_cvt_pk_bf16_f32 v74, v74, v74
v_cvt_pk_bf16_f32 v75, v75, v75
v_cvt_pk_bf16_f32 v76, v76, v76
v_cvt_pk_bf16_f32 v77, v77, v77
v_cvt_pk_bf16_f32 v78, v78, v78
v_cvt_pk_bf16_f32 v79, v79, v79
v_mov_b32 v88, 0
v_mov_b32 v89, 0
v_mov_b32 v90, 0
v_mov_b32 v91, 0
s_lshl_b32 s72, s95, 10
v_lshlrev_b32 v5, 4, v1
v_add_u32 v5, s72, v5
v_and_b32 v80, v68, v124
v_and_b32 v81, v68, v125
v_and_b32 v82, v68, v126
v_and_b32 v83, v68, v127
s_waitcnt vmcnt(11)
s_nop 0
v_mfma_f32_16x16x32_bf16 v[88:91], v[80:83], v[8:11], v[88:91]
v_and_b32 v84, v69, v124
v_and_b32 v85, v69, v125
v_and_b32 v86, v69, v126
v_and_b32 v87, v69, v127
s_waitcnt vmcnt(10)
s_nop 0
v_mfma_f32_16x16x32_bf16 v[88:91], v[84:87], v[12:15], v[88:91]
v_and_b32 v80, v70, v124
v_and_b32 v81, v70, v125
v_and_b32 v82, v70, v126
v_and_b32 v83, v70, v127
s_waitcnt vmcnt(9)
s_nop 0
v_mfma_f32_16x16x32_bf16 v[88:91], v[80:83], v[16:19], v[88:91]
v_and_b32 v84, v71, v124
v_and_b32 v85, v71, v125
v_and_b32 v86, v71, v126
v_and_b32 v87, v71, v127
s_waitcnt vmcnt(8)
s_nop 0
v_mfma_f32_16x16x32_bf16 v[88:91], v[84:87], v[20:23], v[88:91]
v_and_b32 v80, v72, v124
v_and_b32 v81, v72, v125
v_and_b32 v82, v72, v126
v_and_b32 v83, v72, v127
s_waitcnt vmcnt(7)
s_nop 0
v_mfma_f32_16x16x32_bf16 v[88:91], v[80:83], v[24:27], v[88:91]
v_and_b32 v84, v73, v124
v_and_b32 v85, v73, v125
v_and_b32 v86, v73, v126
v_and_b32 v87, v73, v127
s_waitcnt vmcnt(6)
s_nop 0
v_mfma_f32_16x16x32_bf16 v[88:91], v[84:87], v[28:31], v[88:91]
v_and_b32 v80, v74, v124
v_and_b32 v81, v74, v125
v_and_b32 v82, v74, v126
v_and_b32 v83, v74, v127
s_waitcnt vmcnt(5)
s_nop 0
v_mfma_f32_16x16x32_bf16 v[88:91], v[80:83], v[32:35], v[88:91]
v_and_b32 v84, v75, v124
v_and_b32 v85, v75, v125
v_and_b32 v86, v75, v126
v_and_b32 v87, v75, v127
s_waitcnt vmcnt(4)
s_nop 0
v_mfma_f32_16x16x32_bf16 v[88:91], v[84:87], v[36:39], v[88:91]
v_and_b32 v80, v76, v124
v_and_b32 v81, v76, v125
v_and_b32 v82, v76, v126
v_and_b32 v83, v76, v127
s_waitcnt vmcnt(3)
s_nop 0
v_mfma_f32_16x16x32_bf16 v[88:91], v[80:83], v[40:43], v[88:91]
v_and_b32 v84, v77, v124
v_and_b32 v85, v77, v125
v_and_b32 v86, v77, v126
v_and_b32 v87, v77, v127
s_waitcnt vmcnt(2)
s_nop 0
v_mfma_f32_16x16x32_bf16 v[88:91], v[84:87], v[44:47], v[88:91]
v_and_b32 v80, v78, v124
v_and_b32 v81, v78, v125
v_and_b32 v82, v78, v126
v_and_b32 v83, v78, v127
s_waitcnt vmcnt(1)
s_nop 0
v_mfma_f32_16x16x32_bf16 v[88:91], v[80:83], v[48:51], v[88:91]
v_and_b32 v84, v79, v124
v_and_b32 v85, v79, v125
v_and_b32 v86, v79, v126
v_and_b32 v87, v79, v127
s_waitcnt vmcnt(0)
s_nop 0
v_mfma_f32_16x16x32_bf16 v[88:91], v[84:87], v[52:55], v[88:91]
s_nop 7
ds_write_b128 v5, v[88:91] offset:4096
v_mov_b32 v7, 0
v_mov_b32 v6, 1
s_waitcnt lgkmcnt(0)
s_mov_b64 s[74:75], exec
s_mov_b64 exec, 1
ds_add_u32 v7, v6 offset:0
s_mov_b64 exec, s[74:75]
s_branch L_auxD
L_auxO:
s_waitcnt lgkmcnt(0)
s_mul_i32 s94, s94, 1664525
s_add_u32 s94, s94, 1013904223
s_barrier
s_branch L_auxD
L_aux67:
s_waitcnt lgkmcnt(0)
s_mul_i32 s94, s94, 1664525
s_add_u32 s94, s94, 1013904223
s_barrier
s_setprio 3
s_cmp_eq_u32 s95, 7
s_cbranch_scc1 L_a7
s_cmp_eq_u32 s36, 2
s_cbranch_scc1 L_a6_h2
s_cmp_eq_u32 s36, 0
s_cbranch_scc1 L_a6_F
s_lshl_b32 s72, s90, 3
s_add_u32 s72, s72, s37
s_lshr_b32 s88, s72, 1
s_and_b32 s89, s72, 1
v_bfe_u32 v8, v1, 1, 4
v_and_b32 v9, 1, v1
v_lshlrev_b32 v9, 4, v9
v_add_u32 v8, v8, v9
v_lshlrev_b32 v8, 4, v8
v_lshrrev_b32 v9, 5, v1
v_mul_u32_u24 v9, 3072, v9
v_add_u32 v8, v8, v9
s_lshl_b32 s72, s88, 11
s_lshl_b32 s73, s89, 10
s_add_u32 s80, s72, s73
s_add_u32 s80, s80, 65536
s_add_u32 s81, s80, 4194304
v_lshlrev_b32 v10, 5, v1
v_mov_b32 v21, s94
v_mov_b32 v23, s94
v_mov_b32 v25, s94
v_mov_b32 v27, s94
v_mov_b32 v7, 0
s_mov_b32 s73, 400000
LW_1:
ds_read_b32 v6, v7 offset:0
s_waitcnt lgkmcnt(0)
v_readfirstlane_b32 s72, v6
s_cmp_ge_u32 s72, 6
s_cbranch_scc1 LWE_2
s_sub_u32 s73, s73, 1
s_cmp_eq_u32 s73, 0
s_cbranch_scc1 LWE_2
s_sleep 1
s_branch LW_1
LWE_2:
ds_read_b128 v[12:15], v8 offset:4096
ds_read_b128 v[32:35], v8 offset:5120
ds_read_b128 v[36:39], v8 offset:6144
s_waitcnt lgkmcnt(1)
v_pk_add_f32 v[12:13], v[12:13], v[32:33]
v_pk_add_f32 v[14:15], v[14:15], v[34:35]
s_waitcnt lgkmcnt(0)
v_pk_add_f32 v[12:13], v[12:13], v[36:37]
v_pk_add_f32 v[14:15], v[14:15], v[38:39]
s_nop 0
v_mov_b32 v16, v12
v_mov_b32 v17, v13
v_mov_b32 v18, v14
v_mov_b32 v19, v15
v_permlane32_swap_b32 v12, v16
v_permlane32_swap_b32 v13, v17
v_permlane32_swap_b32 v14, v18
v_permlane32_swap_b32 v15, v19
s_nop 0
v_add_f32 v20, v12, v16
v_add_f32 v22, v13, v17
v_add_f32 v24, v14, v18
v_add_f32 v26, v15, v19
s_mov_b32 exec_hi, 0
buffer_store_dwordx4 v[20:23], v10, s[96:99], s80 offen
buffer_store_dwordx4 v[24:27], v10, s[96:99], s80 offen offset:16
buffer_store_dwordx4 v[20:23], v10, s[96:99], s81 offen sc1
buffer_store_dwordx4 v[24:27], v10, s[96:99], s81 offen offset:16 sc1
s_mov_b64 exec, -1
s_cmp_lt_u32 s90, 4
s_cbranch_scc1 L_a6_h2
s_cmp_eq_u32 s37, 0
s_cbranch_scc1 L_h3_slot16
s_branch L_fin
L_a6_F:
s_add_u32 s72, s39, s91
s_lshr_b32 s88, s72, 2
s_and_b32 s89, s72, 3
v_lshrrev_b32 v10, 4, v1
s_and_b32 s72, s91, 0xfc
v_add_u32 v40, s72, v10
v_lshlrev_b32 v40, 3, v40
v_add_u32 v40, s90, v40
v_lshlrev_b32 v40, 3, v40
s_mov_b32 s73, 40000
XT_3:
buffer_load_dwordx2 v[42:43], v40, s[96:99], s100 offen sc1
s_waitcnt vmcnt(0)
v_cmp_ne_u32 vcc, s94, v43
s_cmp_eq_u64 vcc, 0
s_cbranch_scc1 XTE_4
s_sub_u32 s73, s73, 1
s_cmp_eq_u32 s73, 0
s_cbranch_scc1 XTE_4
s_sleep 2
s_branch XT_3
XTE_4:
v_cmp_ne_u32 vcc, s101, v42
s_cmp_eq_u64 vcc, 0
s_cselect_b32 s86, 0, 4194304
v_lshlrev_b32 v8, 2, v10
v_bfe_u32 v9, v1, 1, 2
v_add_u32 v8, v8, v9
v_and_b32 v9, 1, v1
v_lshlrev_b32 v9, 4, v9
v_add_u32 v8, v8, v9
v_lshlrev_b32 v8, 4, v8
v_bfe_u32 v9, v1, 3, 1
v_mul_u32_u24 v9, 3072, v9
v_add_u32 v8, v8, v9
v_cmp_ne_u32 s[76:77], s89, v10
v_and_b32 v9, 15, v1
v_lshlrev_b32 v9, 5, v9
v_lshlrev_b32 v11, 11, v10
v_add_u32 v11, v11, v9
v_lshlrev_b32 v10, 9, v10
v_add_u32 v9, v10, v9
s_lshl_b32 s72, s88, 13
s_add_u32 s72, s72, 131072
s_lshl_b32 s73, s89, 9
s_add_u32 s80, s72, s73
s_add_u32 s82, s80, 4194304
s_lshl_b32 s73, s89, 11
s_add_u32 s81, s72, s73
s_add_u32 s81, s81, s86
v_mov_b32 v21, s94
v_mov_b32 v23, s94
v_mov_b32 v25, s94
v_mov_b32 v27, s94
s_mov_b32 s78, 0x80008000
s_mov_b32 s79, 0x80008000
s_and_b64 s[78:79], s[78:79], s[76:77]
v_mov_b32 v7, 0
s_mov_b32 s73, 400000
LW_5:
ds_read_b32 v6, v7 offset:0
s_waitcnt lgkmcnt(0)
v_readfirstlane_b32 s72, v6
s_cmp_ge_u32 s72, 6
s_cbranch_scc1 LWE_6
s_sub_u32 s73, s73, 1
s_cmp_eq_u32 s73, 0
s_cbranch_scc1 LWE_6
s_sleep 1
s_branch LW_5
LWE_6:
ds_read_b128 v[12:15], v8 offset:4096
ds_read_b128 v[32:35], v8 offset:5120
ds_read_b128 v[36:39], v8 offset:6144
s_waitcnt lgkmcnt(1)
v_pk_add_f32 v[12:13], v[12:13], v[32:33]
v_pk_add_f32 v[14:15], v[14:15], v[34:35]
s_waitcnt lgkmcnt(0)
v_pk_add_f32 v[12:13], v[12:13], v[36:37]
v_pk_add_f32 v[14:15], v[14:15], v[38:39]
s_nop 0
v_mov_b32 v20, v12
v_mov_b32 v22, v13
v_mov_b32 v24, v14
v_mov_b32 v26, v15
s_mov_b64 exec, s[76:77]
buffer_store_dwordx4 v[20:23], v11, s[96:99], s80 offen
buffer_store_dwordx4 v[24:27], v11, s[96:99], s80 offen offset:16
buffer_store_dwordx4 v[20:23], v11, s[96:99], s82 offen sc1
buffer_store_dwordx4 v[24:27], v11, s[96:99], s82 offen offset:16 sc1
s_mov_b32 s73, 40000
XP_7:
buffer_load_dwordx4 v[28:31], v9, s[96:99], s81 offen sc1
buffer_load_dwordx4 v[32:35], v9, s[96:99], s81 offen offset:16 sc1
s_waitcnt vmcnt(0)
v_cmp_ne_u32 vcc, s94, v29
v_cmp_ne_u32 s[74:75], s94, v31
s_or_b64 vcc, vcc, s[74:75]
v_cmp_ne_u32 s[74:75], s94, v33
s_or_b64 vcc, vcc, s[74:75]
v_cmp_ne_u32 s[74:75], s94, v35
s_or_b64 vcc, vcc, s[74:75]
s_cmp_eq_u64 vcc, 0
s_cbranch_scc1 XPE_8
s_sub_u32 s73, s73, 1
s_cmp_eq_u32 s73, 0
s_cbranch_scc1 XPE_8
s_sleep 4
s_branch XP_7
XPE_8:
v_mov_b32 v12, v28
v_mov_b32 v13, v30
v_mov_b32 v14, v32
v_mov_b32 v15, v34
s_mov_b64 exec, -1
v_mov_b32 v16, v12
v_mov_b32 v17, v13
v_mov_b32 v18, v14
v_mov_b32 v19, v15
v_permlane16_swap_b32 v12, v16
v_permlane16_swap_b32 v13, v17
v_permlane16_swap_b32 v14, v18
v_permlane16_swap_b32 v15, v19
s_nop 0
v_add_f32 v12, v12, v16
v_add_f32 v13, v13, v17
v_add_f32 v14, v14, v18
v_add_f32 v15, v15, v19
v_mov_b32 v16, v12
v_mov_b32 v17, v13
v_mov_b32 v18, v14
v_mov_b32 v19, v15
v_permlane32_swap_b32 v12, v16
v_permlane32_swap_b32 v13, v17
v_permlane32_swap_b32 v14, v18
v_permlane32_swap_b32 v15, v19
s_nop 0
v_add_f32 v12, v12, v16
v_add_f32 v13, v13, v17
v_add_f32 v14, v14, v18
v_add_f32 v15, v15, v19
s_nop 0
v_mov_b32_dpp v16, v12 row_ror:8 row_mask:0xf bank_mask:0xf
v_mov_b32_dpp v17, v13 row_ror:8 row_mask:0xf bank_mask:0xf
v_mov_b32_dpp v18, v14 row_ror:8 row_mask:0xf bank_mask:0xf
v_mov_b32_dpp v19, v15 row_ror:8 row_mask:0xf bank_mask:0xf
v_cvt_pk_bf16_f32 v12, v12, v12
v_and_b32 v12, 0xffff0000, v12
v_cvt_pk_bf16_f32 v16, v16, v16
v_and_b32 v16, 0xffff0000, v16
v_cvt_pk_bf16_f32 v13, v13, v13
v_and_b32 v13, 0xffff0000, v13
v_cvt_pk_bf16_f32 v17, v17, v17
v_and_b32 v17, 0xffff0000, v17
v_cvt_pk_bf16_f32 v14, v14, v14
v_and_b32 v14, 0xffff0000, v14
v_cvt_pk_bf16_f32 v18, v18, v18
v_and_b32 v18, 0xffff0000, v18
v_cvt_pk_bf16_f32 v15, v15, v15
v_and_b32 v15, 0xffff0000, v15
v_cvt_pk_bf16_f32 v19, v19, v19
v_and_b32 v19, 0xffff0000, v19
v_mul_f32 v20, 0xbfb8aa3b, v12
v_mul_f32 v21, 0xbfb8aa3b, v13
v_mul_f32 v22, 0xbfb8aa3b, v14
v_mul_f32 v23, 0xbfb8aa3b, v15
v_exp_f32 v20, v20
v_exp_f32 v21, v21
v_exp_f32 v22, v22
v_exp_f32 v23, v23
v_add_f32 v20, 1.0, v20
v_add_f32 v21, 1.0, v21
v_add_f32 v22, 1.0, v22
v_add_f32 v23, 1.0, v23
v_rcp_f32 v20, v20
v_rcp_f32 v21, v21
v_rcp_f32 v22, v22
v_rcp_f32 v23, v23
v_mul_f32 v20, v20, v12
v_mul_f32 v21, v21, v13
v_mul_f32 v22, v22, v14
v_mul_f32 v23, v23, v15
v_cvt_pk_bf16_f32 v20, v20, v20
v_and_b32 v20, 0xffff0000, v20
v_cvt_pk_bf16_f32 v21, v21, v21
v_and_b32 v21, 0xffff0000, v21
v_cvt_pk_bf16_f32 v22, v22, v22
v_and_b32 v22, 0xffff0000, v22
v_cvt_pk_bf16_f32 v23, v23, v23
v_and_b32 v23, 0xffff0000, v23
v_mul_f32 v20, v20, v16
v_mul_f32 v21, v21, v17
v_mul_f32 v22, v22, v18
v_mul_f32 v23, v23, v19
v_cvt_pk_bf16_f32 v20, v20, v20
v_cvt_pk_bf16_f32 v21, v21, v21
v_cvt_pk_bf16_f32 v22, v22, v22
v_cvt_pk_bf16_f32 v23, v23, v23
v_lshlrev_b32 v8, 4, v1
s_mov_b64 exec, 0xff
ds_write_b128 v8, v[20:23] offset:1920
s_mov_b64 exec, -1
v_mov_b32 v7, 0
v_mov_b32 v6, 1
s_waitcnt lgkmcnt(0)
s_mov_b64 s[74:75], exec
s_mov_b64 exec, 1
ds_add_u32 v7, v6 offset:16
s_mov_b64 exec, s[74:75]
s_branch L_fin
L_a6_h2:
s_mov_b32 s86, 0
L_h2:
s_cmp_eq_u32 s36, 2
s_cbranch_scc1 L_h2_O
s_add_u32 s85, s37, 8
s_branch L_h2_go
L_h2_O:
s_lshl_b32 s85, s37, 1
s_add_u32 s85, s85, s86
L_h2_go:
s_lshl_b32 s72, s90, 4
s_add_u32 s85, s85, s72
s_lshr_b32 s84, s85, 2
s_and_b32 s83, s85, 3
s_lshr_b32 s72, s84, 1
s_and_b32 s73, s72, 1
s_lshl_b32 s73, s73, 7
s_lshr_b32 s72, s72, 1
s_add_u32 s72, s72, s73
v_and_b32 v40, 15, v1
v_lshlrev_b32 v40, 3, v40
v_add_u32 v40, s72, v40
v_lshlrev_b32 v40, 3, v40
s_mov_b32 s73, 40000
XT_9:
buffer_load_dwordx2 v[42:43], v40, s[96:99], s100 offen sc1
s_waitcnt vmcnt(0)
v_cmp_ne_u32 vcc, s94, v43
s_cmp_eq_u64 vcc, 0
s_cbranch_scc1 XTE_10
s_sub_u32 s73, s73, 1
s_cmp_eq_u32 s73, 0
s_cbranch_scc1 XTE_10
s_sleep 2
s_branch XT_9
XTE_10:
v_cmp_ne_u32 vcc, s101, v42
s_cmp_eq_u64 vcc, 0
s_cselect_b32 s87, 0, 4194304
s_lshl_b32 s72, s84, 13
s_lshl_b32 s73, s83, 7
s_add_u32 s80, s72, s73
s_add_u32 s80, s80, 458752
s_add_u32 s80, s80, s87
s_add_u32 s81, s80, 4096
v_lshrrev_b32 v8, 3, v1
v_lshlrev_b32 v9, 9, v8
v_and_b32 v10, 7, v1
v_lshlrev_b32 v10, 4, v10
v_add_u32 v9, v9, v10
v_lshlrev_b32 v8, 4, v8
s_lshl_b32 s82, s84, 7
s_add_u32 s82, s82, 425984
s_add_u32 s82, s82, s87
s_lshl_b32 s72, s86, 7
v_lshlrev_b32 v11, 4, v1
v_add_u32 v11, s72, v11
v_mov_b32 v7, 0
s_mov_b32 s73, 400000
LW_11:
ds_read_b32 v6, v7 offset:12
s_waitcnt lgkmcnt(0)
v_readfirstlane_b32 s72, v6
s_cmp_ge_u32 s72, 8
s_cbranch_scc1 LWE_12
s_sub_u32 s73, s73, 1
s_cmp_eq_u32 s73, 0
s_cbranch_scc1 LWE_12
s_sleep 1
s_branch LW_11
LWE_12:
s_mov_b32 s73, 40000
HP_13:
buffer_load_dwordx4 v[20:23], v8, s[96:99], s82 offen sc1
buffer_load_dwordx4 v[12:15], v9, s[96:99], s80 offen sc1
buffer_load_dwordx4 v[16:19], v9, s[96:99], s81 offen sc1
s_waitcnt vmcnt(0)
v_cmp_ne_u32 vcc, s94, v21
v_cmp_ne_u32 s[74:75], s94, v23
s_or_b64 vcc, vcc, s[74:75]
v_cmp_ne_u32 s[74:75], s94, v13
s_or_b64 vcc, vcc, s[74:75]
v_cmp_ne_u32 s[74:75], s94, v15
s_or_b64 vcc, vcc, s[74:75]
v_cmp_ne_u32 s[74:75], s94, v17
s_or_b64 vcc, vcc, s[74:75]
v_cmp_ne_u32 s[74:75], s94, v19
s_or_b64 vcc, vcc, s[74:75]
s_cmp_eq_u64 vcc, 0
s_cbranch_scc1 HPE_14
s_sub_u32 s73, s73, 1
s_cmp_eq_u32 s73, 0
s_cbranch_scc1 HPE_14
s_branch HP_13
HPE_14:
v_max_f32 v24, v20, v22
v_lshlrev_b32 v26, 16, v12
v_and_b32 v27, 0xffff0000, v12
v_max_f32_dpp v24, v24, v24 row_ror:8 row_mask:0xf bank_mask:0xf
v_lshlrev_b32 v28, 16, v14
v_and_b32 v29, 0xffff0000, v14
v_mov_b32 v25, v24
v_lshlrev_b32 v30, 16, v16
v_and_b32 v31, 0xffff0000, v16
v_permlane16_swap_b32 v24, v25
v_lshlrev_b32 v32, 16, v18
v_max_f32 v24, v24, v25
v_and_b32 v33, 0xffff0000, v18
v_mov_b32 v25, v24
s_nop 1
v_permlane32_swap_b32 v24, v25
s_nop 0
v_max_f32 v24, v24, v25
v_sub_f32 v20, v20, v24
v_sub_f32 v22, v22, v24
v_exp_f32 v20, v20
v_exp_f32 v22, v22
s_nop 0
v_add_f32 v24, v20, v22
v_mul_f32 v26, v26, v20
v_mul_f32 v27, v27, v20
v_mul_f32 v28, v28, v20
v_mul_f32 v29, v29, v20
v_fma_f32 v26, v30, v22, v26
v_fma_f32 v27, v31, v22, v27
v_fma_f32 v28, v32, v22, v28
v_fma_f32 v29, v33, v22, v29
v_add_f32_dpp v24, v24, v24 row_ror:8 row_mask:0xf bank_mask:0xf
v_add_f32_dpp v26, v26, v26 row_ror:8 row_mask:0xf bank_mask:0xf
v_add_f32_dpp v27, v27, v27 row_ror:8 row_mask:0xf bank_mask:0xf
v_add_f32_dpp v28, v28, v28 row_ror:8 row_mask:0xf bank_mask:0xf
v_add_f32_dpp v29, v29, v29 row_ror:8 row_mask:0xf bank_mask:0xf
v_mov_b32 v34, v24
v_mov_b32 v35, v26
v_mov_b32 v36, v27
v_mov_b32 v37, v28
v_mov_b32 v38, v29
v_permlane16_swap_b32 v24, v34
v_permlane16_swap_b32 v26, v35
v_permlane16_swap_b32 v27, v36
v_permlane16_swap_b32 v28, v37
v_permlane16_swap_b32 v29, v38
s_nop 0
v_add_f32 v24, v24, v34
v_add_f32 v26, v26, v35
v_add_f32 v27, v27, v36
v_add_f32 v28, v28, v37
v_add_f32 v29, v29, v38
v_mov_b32 v34, v24
v_mov_b32 v35, v26
v_mov_b32 v36, v27
v_mov_b32 v37, v28
v_mov_b32 v38, v29
v_permlane32_swap_b32 v24, v34
v_permlane32_swap_b32 v26, v35
v_permlane32_swap_b32 v27, v36
v_permlane32_swap_b32 v28, v37
v_permlane32_swap_b32 v29, v38
s_nop 0
v_add_f32 v24, v24, v34
v_add_f32 v26, v26, v35
v_add_f32 v27, v27, v36
v_add_f32 v28, v28, v37
v_add_f32 v29, v29, v38
v_rcp_f32 v24, v24
s_nop 0
v_mul_f32 v26, v26, v24
v_mul_f32 v27, v27, v24
v_mul_f32 v28, v28, v24
v_mul_f32 v29, v29, v24
v_cvt_pk_bf16_f32 v26, v26, v26
v_cvt_pk_bf16_f32 v27, v27, v27
v_cvt_pk_bf16_f32 v28, v28, v28
v_cvt_pk_bf16_f32 v29, v29, v29
s_mov_b64 exec, 0xff
ds_write_b128 v11, v[26:29] offset:1920
s_mov_b64 exec, -1
s_cmp_eq_u32 s86, 0
s_cbranch_scc1 L_h2_f0
v_mov_b32 v7, 0
v_mov_b32 v6, 1
s_waitcnt lgkmcnt(0)
s_mov_b64 s[74:75], exec
s_mov_b64 exec, 1
ds_add_u32 v7, v6 offset:20
s_mov_b64 exec, s[74:75]
s_branch L_fin
L_h2_f0:
v_mov_b32 v7, 0
v_mov_b32 v6, 1
s_waitcnt lgkmcnt(0)
s_mov_b64 s[74:75], exec
s_mov_b64 exec, 1
ds_add_u32 v7, v6 offset:16
s_mov_b64 exec, s[74:75]
s_cmp_eq_u32 s36, 2
s_cbranch_scc1 L_h3_slot16
s_cmp_lt_u32 s37, 5
s_cbranch_scc1 L_h3_slot16
s_branch L_fin
L_a7:
s_and_b32 s72, s92, 1
s_lshl_b32 s72, s72, 2
s_add_u32 s72, s72, s38
s_lshl_b32 s72, s72, 3
s_lshr_b32 s73, s92, 1
s_add_u32 s72, s72, s73
v_and_b32 v40, 3, v1
v_lshlrev_b32 v40, 3, v40
v_add_u32 v40, s72, v40
v_lshlrev_b32 v40, 3, v40
s_lshl_b32 s72, s92, 12
s_add_u32 s80, s72, 65536
s_add_u32 s81, s72, 4259840
v_lshlrev_b32 v8, 4, v1
v_lshlrev_b32 v10, 2, v1
s_cmp_eq_u32 s36, 2
s_cbranch_scc1 L_q_nw
v_mov_b32 v7, 0
s_mov_b32 s73, 400000
LW_15:
ds_read_b32 v6, v7 offset:0
s_waitcnt lgkmcnt(0)
v_readfirstlane_b32 s72, v6
s_cmp_ge_u32 s72, 6
s_cbranch_scc1 LWE_16
s_sub_u32 s73, s73, 1
s_cmp_eq_u32 s73, 0
s_cbranch_scc1 LWE_16
s_sleep 2
s_branch LW_15
LWE_16:
L_q_nw:
s_mov_b32 s82, s80
s_mov_b32 s73, 40000
buffer_load_dwordx4 v[12:15], v8, s[96:99], s80 offen offset:0 sc1
buffer_load_dwordx4 v[16:19], v8, s[96:99], s80 offen offset:1024 sc1
buffer_load_dwordx4 v[20:23], v8, s[96:99], s80 offen offset:2048 sc1
buffer_load_dwordx4 v[24:27], v8, s[96:99], s80 offen offset:3072 sc1
buffer_load_dwordx2 v[42:43], v40, s[96:99], s100 offen sc1
L_qp_loop:
buffer_load_dwordx4 v[44:47], v8, s[96:99], s80 offen offset:0 sc1
buffer_load_dwordx4 v[48:51], v8, s[96:99], s80 offen offset:1024 sc1
buffer_load_dwordx4 v[52:55], v8, s[96:99], s80 offen offset:2048 sc1
buffer_load_dwordx4 v[56:59], v8, s[96:99], s80 offen offset:3072 sc1
buffer_load_dwordx2 v[60:61], v40, s[96:99], s100 offen sc1
s_waitcnt vmcnt(5)
v_cmp_ne_u32 vcc, s94, v13
v_cmp_ne_u32 s[74:75], s94, v15
s_or_b64 vcc, vcc, s[74:75]
v_cmp_ne_u32 s[74:75], s94, v17
s_or_b64 vcc, vcc, s[74:75]
v_cmp_ne_u32 s[74:75], s94, v19
s_or_b64 vcc, vcc, s[74:75]
v_cmp_ne_u32 s[74:75], s94, v21
s_or_b64 vcc, vcc, s[74:75]
v_cmp_ne_u32 s[74:75], s94, v23
s_or_b64 vcc, vcc, s[74:75]
v_cmp_ne_u32 s[74:75], s94, v25
s_or_b64 vcc, vcc, s[74:75]
v_cmp_ne_u32 s[74:75], s94, v27
s_or_b64 vcc, vcc, s[74:75]
s_cmp_eq_u64 vcc, 0
s_cbranch_scc1 L_qp_d0
s_sub_u32 s73, s73, 1
s_cmp_eq_u32 s73, 0
s_cbranch_scc1 L_qp_d0
v_cmp_ne_u32 vcc, s94, v43
s_cmp_eq_u64 vcc, 0
s_cbranch_scc0 L_qp_n0
v_cmp_ne_u32 vcc, s101, v42
s_cmp_eq_u64 vcc, 0
s_cselect_b32 s80, s82, s81
L_qp_n0:
buffer_load_dwordx4 v[12:15], v8, s[96:99], s80 offen offset:0 sc1
buffer_load_dwordx4 v[16:19], v8, s[96:99], s80 offen offset:1024 sc1
buffer_load_dwordx4 v[20:23], v8, s[96:99], s80 offen offset:2048 sc1
buffer_load_dwordx4 v[24:27], v8, s[96:99], s80 offen offset:3072 sc1
buffer_load_dwordx2 v[42:43], v40, s[96:99], s100 offen sc1
s_waitcnt vmcnt(5)
v_cmp_ne_u32 vcc, s94, v45
v_cmp_ne_u32 s[74:75], s94, v47
s_or_b64 vcc, vcc, s[74:75]
v_cmp_ne_u32 s[74:75], s94, v49
s_or_b64 vcc, vcc, s[74:75]
v_cmp_ne_u32 s[74:75], s94, v51
s_or_b64 vcc, vcc, s[74:75]
v_cmp_ne_u32 s[74:75], s94, v53
s_or_b64 vcc, vcc, s[74:75]
v_cmp_ne_u32 s[74:75], s94, v55
s_or_b64 vcc, vcc, s[74:75]
v_cmp_ne_u32 s[74:75], s94, v57
s_or_b64 vcc, vcc, s[74:75]
v_cmp_ne_u32 s[74:75], s94, v59
s_or_b64 vcc, vcc, s[74:75]
s_cmp_eq_u64 vcc, 0
s_cbranch_scc1 L_qp_d1
s_sub_u32 s73, s73, 1
s_cmp_eq_u32 s73, 0
s_cbranch_scc1 L_qp_d1
v_cmp_ne_u32 vcc, s94, v61
s_cmp_eq_u64 vcc, 0
s_cbranch_scc0 L_qp_n1
v_cmp_ne_u32 vcc, s101, v60
s_cmp_eq_u64 vcc, 0
s_cselect_b32 s80, s82, s81
L_qp_n1:
s_branch L_qp_loop
L_qp_d1:
v_add_f32 v44, v44, v48
v_add_f32 v46, v46, v50
v_add_f32 v52, v52, v56
v_add_f32 v54, v54, v58
v_cvt_pk_bf16_f32 v62, v44, v46
v_cvt_pk_bf16_f32 v63, v52, v54
ds_write_b32 v10, v62 offset:1280
ds_write_b32 v10, v63 offset:1536
s_branch L_qp_e
L_qp_d0:
v_add_f32 v12, v12, v16
v_add_f32 v14, v14, v18
v_add_f32 v20, v20, v24
v_add_f32 v22, v22, v26
v_cvt_pk_bf16_f32 v62, v12, v14
v_cvt_pk_bf16_f32 v63, v20, v22
ds_write_b32 v10, v62 offset:1280
ds_write_b32 v10, v63 offset:1536
L_qp_e:
v_mov_b32 v7, 0
v_mov_b32 v6, 1
s_waitcnt lgkmcnt(0)
s_mov_b64 s[74:75], exec
s_mov_b64 exec, 1
ds_add_u32 v7, v6 offset:8
s_mov_b64 exec, s[74:75]
s_cmp_eq_u32 s36, 2
s_cbranch_scc0 L_fin
s_mov_b32 s86, 1
s_branch L_h2
L_auxD:
s_mov_b32 s86, 0
s_mov_b32 s84, s95
s_cmp_eq_u32 s36, 2
s_cbranch_scc1 L_D_O
s_cmp_ge_u32 s95, 3
s_cbranch_scc1 L_fin
s_cmp_eq_u32 s36, 1
s_cbranch_scc1 L_D_Q
s_mov_b32 s28, s20
s_mov_b32 s29, s21
s_mov_b32 s30, 5308416
s_mov_b32 s31, 0x20000
s_add_u32 s85, s39, s91
s_mov_b32 s83, s85
s_branch L_D_go
L_D_Q:
s_cmp_ge_u32 s90, 4
s_cbranch_scc1 L_fin
s_add_u32 s85, s37, 8
s_branch L_D_wo
L_D_O:
s_cmp_ge_u32 s95, 3
s_cselect_b32 s86, 1, 0
s_mul_i32 s72, s86, 3
s_sub_u32 s84, s95, s72
s_lshl_b32 s85, s37, 1
s_add_u32 s85, s85, s86
L_D_wo:
s_mov_b32 s28, s12
s_mov_b32 s29, s13
s_mov_b32 s30, 4718592
s_mov_b32 s31, 0x20000
s_lshl_b32 s72, s90, 4
s_add_u32 s85, s85, s72
s_add_u32 s83, s85, 144
L_D_go:
s_setprio 0
v_lshrrev_b32 v3, 4, v1
v_lshlrev_b32 v3, 1, v3
v_bfe_u32 v4, v1, 3, 1
v_add_u32 v3, v3, v4
v_and_b32 v4, 7, v1
v_lshlrev_b32 v4, 4, v4
s_mul_i32 s72, s85, 36864
s_mul_i32 s73, s84, 384
s_add_u32 s82, s72, s73
v_mul_u32_u24 v5, 1152, v3
v_add_u32 v5, v5, v4
v_add_u32 v5, s82, v5
s_lshl_b32 s72, s86, 7
v_lshlrev_b32 v100, 2, v3
v_add_u32 v100, s72, v100
v_bfe_u32 v101, v1, 3, 1
v_lshrrev_b32 v102, 5, v1
v_cmp_eq_u32 s[78:79], v101, v102
v_mul_u32_u24 v101, 768, v102
v_and_b32 v102, 7, v1
v_lshlrev_b32 v102, 5, v102
v_add_u32 v101, v101, v102
v_bfe_u32 v102, v1, 4, 1
v_lshlrev_b32 v102, 4, v102
v_add_u32 v101, v101, v102
s_mul_i32 s72, s95, 1536
v_add_u32 v101, s72, v101
v_lshlrev_b32 v102, 3, v1
v_add_u32 v102, s72, v102
s_mul_i32 s72, s83, 4608
s_mul_i32 s73, s84, 1536
s_add_u32 s80, s72, s73
s_add_u32 s80, s80, 786432
v_lshlrev_b32 v103, 4, v1
v_mov_b32 v105, s94
v_mov_b32 v107, s94
v_mov_b32 v109, s94
v_mov_b32 v111, s94
v_mov_b32 v88, 0
v_mov_b32 v89, 0
v_mov_b32 v90, 0
v_mov_b32 v91, 0
v_mov_b32 v92, 0
v_mov_b32 v93, 0
v_mov_b32 v94, 0
v_mov_b32 v95, 0
v_mov_b32 v96, 0
v_mov_b32 v97, 0
v_mov_b32 v98, 0
v_mov_b32 v99, 0
s_cmp_lg_u32 s36, 0
s_cbranch_scc1 L_D_g1
v_mov_b32 v7, 0
s_mov_b32 s73, 400000
LW_17:
ds_read_b32 v6, v7 offset:28
s_waitcnt lgkmcnt(0)
v_readfirstlane_b32 s72, v6
s_cmp_ge_u32 s72, 1
s_cbranch_scc1 LWE_18
s_sub_u32 s73, s73, 1
s_cmp_eq_u32 s73, 0
s_cbranch_scc1 LWE_18
s_sleep 1
s_branch LW_17
LWE_18:
s_branch L_D_g2
L_D_g1:
v_mov_b32 v7, 0
s_mov_b32 s73, 400000
LW_19:
ds_read_b32 v6, v7 offset:4
s_waitcnt lgkmcnt(0)
v_readfirstlane_b32 s72, v6
s_cmp_ge_u32 s72, 8
s_cbranch_scc1 LWE_20
s_sub_u32 s73, s73, 1
s_cmp_eq_u32 s73, 0
s_cbranch_scc1 LWE_20
s_sleep 2
s_branch LW_19
LWE_20:
L_D_g2:
s_cmp_eq_u32 s36, 2
s_cbranch_scc1 L_D_ldO
s_mov_b32 s77, 0
buffer_load_dwordx4 v[8:11], v5, s[28:31], s77 offen offset:0 nt
buffer_load_dwordx4 v[12:15], v5, s[28:31], s77 offen offset:128 nt
buffer_load_dwordx4 v[16:19], v5, s[28:31], s77 offen offset:256 nt
s_add_u32 s77, s77, 9216
buffer_load_dwordx4 v[20:23], v5, s[28:31], s77 offen offset:0 nt
buffer_load_dwordx4 v[24:27], v5, s[28:31], s77 offen offset:128 nt
buffer_load_dwordx4 v[28:31], v5, s[28:31], s77 offen offset:256 nt
s_add_u32 s77, s77, 9216
buffer_load_dwordx4 v[32:35], v5, s[28:31], s77 offen offset:0 nt
buffer_load_dwordx4 v[36:39], v5, s[28:31], s77 offen offset:128 nt
buffer_load_dwordx4 v[40:43], v5, s[28:31], s77 offen offset:256 nt
s_add_u32 s77, s77, 9216
buffer_load_dwordx4 v[44:47], v5, s[28:31], s77 offen offset:0 nt
buffer_load_dwordx4 v[48:51], v5, s[28:31], s77 offen offset:128 nt
buffer_load_dwordx4 v[52:55], v5, s[28:31], s77 offen offset:256 nt
s_branch L_D_ldE
L_D_ldO:
s_mov_b32 s77, 0
buffer_load_dwordx4 v[8:11], v5, s[28:31], s77 offen offset:0 nt
buffer_load_dwordx4 v[12:15], v5, s[28:31], s77 offen offset:128 nt
buffer_load_dwordx4 v[16:19], v5, s[28:31], s77 offen offset:256 nt
s_add_u32 s77, s77, 9216
buffer_load_dwordx4 v[20:23], v5, s[28:31], s77 offen offset:0 nt
buffer_load_dwordx4 v[24:27], v5, s[28:31], s77 offen offset:128 nt
buffer_load_dwordx4 v[28:31], v5, s[28:31], s77 offen offset:256 nt
s_add_u32 s77, s77, 9216
s_waitcnt vmcnt(5)
buffer_load_dwordx4 v[32:35], v5, s[28:31], s77 offen offset:0 nt
s_waitcnt vmcnt(5)
buffer_load_dwordx4 v[36:39], v5, s[28:31], s77 offen offset:128 nt
s_waitcnt vmcnt(5)
buffer_load_dwordx4 v[40:43], v5, s[28:31], s77 offen offset:256 nt
s_add_u32 s77, s77, 9216
s_waitcnt vmcnt(5)
buffer_load_dwordx4 v[44:47], v5, s[28:31], s77 offen offset:0 nt
s_waitcnt vmcnt(5)
buffer_load_dwordx4 v[48:51], v5, s[28:31], s77 offen offset:128 nt
s_waitcnt vmcnt(5)
buffer_load_dwordx4 v[52:55], v5, s[28:31], s77 offen offset:256 nt
L_D_ldE:
s_setprio 2
s_cmp_eq_u32 s86, 0
s_cbranch_scc1 L_D_w0
v_mov_b32 v7, 0
s_mov_b32 s73, 400000
LW_21:
ds_read_b32 v6, v7 offset:20
s_waitcnt lgkmcnt(0)
v_readfirstlane_b32 s72, v6
s_cmp_ge_u32 s72, 1
s_cbranch_scc1 LWE_22
s_sub_u32 s73, s73, 1
s_cmp_eq_u32 s73, 0
s_cbranch_scc1 LWE_22
s_branch LW_21
LWE_22:
s_branch L_D_w1
L_D_w0:
v_mov_b32 v7, 0
s_mov_b32 s73, 400000
LW_23:
ds_read_b32 v6, v7 offset:16
s_waitcnt lgkmcnt(0)
v_readfirstlane_b32 s72, v6
s_cmp_ge_u32 s72, 1
s_cbranch_scc1 LWE_24
s_sub_u32 s73, s73, 1
s_cmp_eq_u32 s73, 0
s_cbranch_scc1 LWE_24
s_branch LW_23
LWE_24:
L_D_w1:
ds_read_b32 v68, v100 offset:1920
ds_read_b32 v69, v100 offset:1952
ds_read_b32 v70, v100 offset:1984
ds_read_b32 v71, v100 offset:2016
s_waitcnt lgkmcnt(3)
v_and_b32 v80, v68, v124
v_and_b32 v81, v68, v125
v_and_b32 v82, v68, v126
v_and_b32 v83, v68, v127
s_waitcnt vmcnt(11)
s_nop 0
v_mfma_f32_16x16x32_bf16 v[88:91], v[80:83], v[8:11], v[88:91]
s_waitcnt vmcnt(10)
v_mfma_f32_16x16x32_bf16 v[92:95], v[80:83], v[12:15], v[92:95]
s_waitcnt vmcnt(9)
v_mfma_f32_16x16x32_bf16 v[96:99], v[80:83], v[16:19], v[96:99]
s_waitcnt lgkmcnt(2)
v_and_b32 v84, v69, v124
v_and_b32 v85, v69, v125
v_and_b32 v86, v69, v126
v_and_b32 v87, v69, v127
s_waitcnt vmcnt(8)
s_nop 0
v_mfma_f32_16x16x32_bf16 v[88:91], v[84:87], v[20:23], v[88:91]
s_waitcnt vmcnt(7)
v_mfma_f32_16x16x32_bf16 v[92:95], v[84:87], v[24:27], v[92:95]
s_waitcnt vmcnt(6)
v_mfma_f32_16x16x32_bf16 v[96:99], v[84:87], v[28:31], v[96:99]
s_waitcnt lgkmcnt(1)
v_and_b32 v80, v70, v124
v_and_b32 v81, v70, v125
v_and_b32 v82, v70, v126
v_and_b32 v83, v70, v127
s_waitcnt vmcnt(5)
s_nop 0
v_mfma_f32_16x16x32_bf16 v[88:91], v[80:83], v[32:35], v[88:91]
s_waitcnt vmcnt(4)
v_mfma_f32_16x16x32_bf16 v[92:95], v[80:83], v[36:39], v[92:95]
s_waitcnt vmcnt(3)
v_mfma_f32_16x16x32_bf16 v[96:99], v[80:83], v[40:43], v[96:99]
s_waitcnt lgkmcnt(0)
v_and_b32 v84, v71, v124
v_and_b32 v85, v71, v125
v_and_b32 v86, v71, v126
v_and_b32 v87, v71, v127
s_waitcnt vmcnt(2)
s_nop 0
v_mfma_f32_16x16x32_bf16 v[88:91], v[84:87], v[44:47], v[88:91]
s_waitcnt vmcnt(1)
v_mfma_f32_16x16x32_bf16 v[92:95], v[84:87], v[48:51], v[92:95]
s_waitcnt vmcnt(0)
v_mfma_f32_16x16x32_bf16 v[96:99], v[84:87], v[52:55], v[96:99]
s_mov_b64 exec, s[78:79]
s_nop 4
ds_write_b128 v101, v[88:91] offset:20480
ds_write_b128 v101, v[92:95] offset:20736
ds_write_b128 v101, v[96:99] offset:20992
s_mov_b64 exec, -1
s_waitcnt lgkmcnt(0)
ds_read_b64 v[24:25], v102 offset:20480
ds_read_b64 v[26:27], v102 offset:21248
ds_read_b64 v[28:29], v102 offset:20992
ds_read_b64 v[30:31], v102 offset:21760
s_waitcnt lgkmcnt(2)
v_add_f32 v104, v24, v26
v_add_f32 v106, v25, v27
buffer_store_dwordx4 v[104:107], v103, s[96:99], s80 offen sc1
s_waitcnt lgkmcnt(0)
v_add_f32 v108, v28, v30
v_add_f32 v110, v29, v31
s_mov_b32 exec_hi, 0
buffer_store_dwordx4 v[108:111], v103, s[96:99], s80 offen offset:1024 sc1
s_mov_b64 exec, -1
v_mov_b32 v7, 0
v_mov_b32 v6, 1
s_waitcnt lgkmcnt(0)
s_mov_b64 s[74:75], exec
s_mov_b64 exec, 1
ds_add_u32 v7, v6 offset:40
s_mov_b64 exec, s[74:75]
s_branch L_fin
L_KV:
s_sub_u32 s95, s3, 4
s_setprio 1
s_cmp_lg_u32 s95, 0
s_cbranch_scc1 L_KV_ni
v_mov_b32 v5, 0
v_lshlrev_b32 v6, 2, v1
s_mov_b64 exec, 0xffff
ds_write_b32 v6, v5
s_mov_b64 exec, -1
L_KV_ni:
s_mov_b32 s28, s6
s_mov_b32 s29, s7
s_mov_b32 s30, 268435456
s_mov_b32 s31, 0x20000
s_mov_b32 s32, s8
s_mov_b32 s33, s9
s_mov_b32 s34, 268435456
s_mov_b32 s35, 0x20000
s_lshl_b32 s76, s92, 24
s_lshl_b32 s77, s93, 16
s_add_u32 s76, s76, s77
s_add_u32 s76, s76, 15728640
s_lshl_b32 s77, s95, 13
s_add_u32 s76, s76, s77
v_bfe_u32 v3, v1, 2, 2
v_lshlrev_b32 v3, 8, v3
v_lshrrev_b32 v4, 4, v1
v_lshlrev_b32 v4, 6, v4
v_add_u32 v3, v3, v4
v_and_b32 v4, 3, v1
v_lshlrev_b32 v4, 4, v4
v_add_u32 v3, v3, v4
v_add_u32 v3, s76, v3
v_lshlrev_b32 v4, 4, v1
v_add_u32 v4, s76, v4
s_waitcnt lgkmcnt(0)
s_mul_i32 s94, s94, 1664525
s_add_u32 s94, s94, 1013904223
s_cmp_lg_u32 s95, 1
s_cbranch_scc1 L_KV_nx
v_mov_b32 v6, s101
v_mov_b32 v7, s94
s_lshl_b32 s72, s2, 3
v_mov_b32 v5, s72
s_mov_b64 exec, 1
buffer_store_dwordx2 v[6:7], v5, s[96:99], s100 offen sc1
s_mov_b64 exec, -1
L_KV_nx:
s_barrier
s_cmp_eq_u32 s36, 2
s_cbranch_scc1 L_KV_ng2
s_cmp_eq_u32 s36, 0
s_cselect_b32 s79, 6, 6
v_mov_b32 v7, 0
s_mov_b32 s73, 400000
LW_25:
ds_read_b32 v6, v7 offset:36
s_waitcnt lgkmcnt(0)
v_readfirstlane_b32 s72, v6
s_cmp_ge_u32 s72, s79
s_cbranch_scc1 LWE_26
s_sub_u32 s73, s73, 1
s_cmp_eq_u32 s73, 0
s_cbranch_scc1 LWE_26
s_sleep 1
s_branch LW_25
LWE_26:
L_KV_ng2:
s_add_u32 s78, s95, s93
s_cmp_eq_u32 s36, 2
s_cbranch_scc1 L_KVL_4
L_KVL_6:
s_add_u32 s77, s78, 0
s_and_b32 s77, s77, 7
s_lshl_b32 s77, s77, 10
buffer_load_dwordx4 v[8:11], v3, s[28:31], s77 offen nt
s_add_u32 s77, s78, 1
s_and_b32 s77, s77, 7
s_lshl_b32 s77, s77, 10
buffer_load_dwordx4 v[12:15], v3, s[28:31], s77 offen nt
s_add_u32 s77, s78, 2
s_and_b32 s77, s77, 7
s_lshl_b32 s77, s77, 10
buffer_load_dwordx4 v[16:19], v3, s[28:31], s77 offen nt
s_add_u32 s77, s78, 3
s_and_b32 s77, s77, 7
s_lshl_b32 s77, s77, 10
buffer_load_dwordx4 v[20:23], v3, s[28:31], s77 offen nt
s_add_u32 s77, s78, 4
s_and_b32 s77, s77, 7
s_lshl_b32 s77, s77, 10
buffer_load_dwordx4 v[24:27], v3, s[28:31], s77 offen nt
s_add_u32 s77, s78, 5
s_and_b32 s77, s77, 7
s_lshl_b32 s77, s77, 10
buffer_load_dwordx4 v[28:31], v3, s[28:31], s77 offen nt
s_add_u32 s77, s78, 6
s_and_b32 s77, s77, 7
s_lshl_b32 s77, s77, 10
s_waitcnt vmcnt(5)
buffer_load_dwordx4 v[32:35], v3, s[28:31], s77 offen nt
s_add_u32 s77, s78, 7
s_and_b32 s77, s77, 7
s_lshl_b32 s77, s77, 10
s_waitcnt vmcnt(5)
buffer_load_dwordx4 v[36:39], v3, s[28:31], s77 offen nt
s_add_u32 s77, s78, 0
s_and_b32 s77, s77, 7
s_lshl_b32 s77, s77, 10
s_waitcnt vmcnt(5)
buffer_load_dwordx4 v[40:43], v4, s[32:35], s77 offen nt
s_add_u32 s77, s78, 1
s_and_b32 s77, s77, 7
s_lshl_b32 s77, s77, 10
s_waitcnt vmcnt(5)
buffer_load_dwordx4 v[44:47], v4, s[32:35], s77 offen nt
s_add_u32 s77, s78, 2
s_and_b32 s77, s77, 7
s_lshl_b32 s77, s77, 10
s_waitcnt vmcnt(5)
buffer_load_dwordx4 v[48:51], v4, s[32:35], s77 offen nt
s_add_u32 s77, s78, 3
s_and_b32 s77, s77, 7
s_lshl_b32 s77, s77, 10
s_waitcnt vmcnt(5)
buffer_load_dwordx4 v[52:55], v4, s[32:35], s77 offen nt
s_add_u32 s77, s78, 4
s_and_b32 s77, s77, 7
s_lshl_b32 s77, s77, 10
s_waitcnt vmcnt(5)
buffer_load_dwordx4 v[56:59], v4, s[32:35], s77 offen nt
s_add_u32 s77, s78, 5
s_and_b32 s77, s77, 7
s_lshl_b32 s77, s77, 10
s_waitcnt vmcnt(5)
buffer_load_dwordx4 v[60:63], v4, s[32:35], s77 offen nt
s_add_u32 s77, s78, 6
s_and_b32 s77, s77, 7
s_lshl_b32 s77, s77, 10
s_waitcnt vmcnt(5)
buffer_load_dwordx4 v[64:67], v4, s[32:35], s77 offen nt
s_add_u32 s77, s78, 7
s_and_b32 s77, s77, 7
s_lshl_b32 s77, s77, 10
s_waitcnt vmcnt(5)
buffer_load_dwordx4 v[68:71], v4, s[32:35], s77 offen nt
s_branch L_KVL_e
L_KVL_4:
s_add_u32 s77, s78, 0
s_and_b32 s77, s77, 7
s_lshl_b32 s77, s77, 10
buffer_load_dwordx4 v[8:11], v3, s[28:31], s77 offen nt
s_add_u32 s77, s78, 1
s_and_b32 s77, s77, 7
s_lshl_b32 s77, s77, 10
buffer_load_dwordx4 v[12:15], v3, s[28:31], s77 offen nt
s_add_u32 s77, s78, 2
s_and_b32 s77, s77, 7
s_lshl_b32 s77, s77, 10
buffer_load_dwordx4 v[16:19], v3, s[28:31], s77 offen nt
s_add_u32 s77, s78, 3
s_and_b32 s77, s77, 7
s_lshl_b32 s77, s77, 10
buffer_load_dwordx4 v[20:23], v3, s[28:31], s77 offen nt
s_add_u32 s77, s78, 4
s_and_b32 s77, s77, 7
s_lshl_b32 s77, s77, 10
s_waitcnt vmcnt(3)
buffer_load_dwordx4 v[24:27], v3, s[28:31], s77 offen nt
s_add_u32 s77, s78, 5
s_and_b32 s77, s77, 7
s_lshl_b32 s77, s77, 10
s_waitcnt vmcnt(3)
buffer_load_dwordx4 v[28:31], v3, s[28:31], s77 offen nt
s_add_u32 s77, s78, 6
s_and_b32 s77, s77, 7
s_lshl_b32 s77, s77, 10
s_waitcnt vmcnt(3)
buffer_load_dwordx4 v[32:35], v3, s[28:31], s77 offen nt
s_add_u32 s77, s78, 7
s_and_b32 s77, s77, 7
s_lshl_b32 s77, s77, 10
s_waitcnt vmcnt(3)
buffer_load_dwordx4 v[36:39], v3, s[28:31], s77 offen nt
s_add_u32 s77, s78, 0
s_and_b32 s77, s77, 7
s_lshl_b32 s77, s77, 10
s_waitcnt vmcnt(3)
buffer_load_dwordx4 v[40:43], v4, s[32:35], s77 offen nt
s_add_u32 s77, s78, 1
s_and_b32 s77, s77, 7
s_lshl_b32 s77, s77, 10
s_waitcnt vmcnt(3)
buffer_load_dwordx4 v[44:47], v4, s[32:35], s77 offen nt
s_add_u32 s77, s78, 2
s_and_b32 s77, s77, 7
s_lshl_b32 s77, s77, 10
s_waitcnt vmcnt(3)
buffer_load_dwordx4 v[48:51], v4, s[32:35], s77 offen nt
s_add_u32 s77, s78, 3
s_and_b32 s77, s77, 7
s_lshl_b32 s77, s77, 10
s_waitcnt vmcnt(3)
buffer_load_dwordx4 v[52:55], v4, s[32:35], s77 offen nt
s_add_u32 s77, s78, 4
s_and_b32 s77, s77, 7
s_lshl_b32 s77, s77, 10
s_waitcnt vmcnt(3)
buffer_load_dwordx4 v[56:59], v4, s[32:35], s77 offen nt
s_add_u32 s77, s78, 5
s_and_b32 s77, s77, 7
s_lshl_b32 s77, s77, 10
s_waitcnt vmcnt(3)
buffer_load_dwordx4 v[60:63], v4, s[32:35], s77 offen nt
s_add_u32 s77, s78, 6
s_and_b32 s77, s77, 7
s_lshl_b32 s77, s77, 10
s_waitcnt vmcnt(3)
buffer_load_dwordx4 v[64:67], v4, s[32:35], s77 offen nt
s_add_u32 s77, s78, 7
s_and_b32 s77, s77, 7
s_lshl_b32 s77, s77, 10
s_waitcnt vmcnt(3)
buffer_load_dwordx4 v[68:71], v4, s[32:35], s77 offen nt
L_KVL_e:
v_mov_b32 v7, 0
v_mov_b32 v6, 1
s_waitcnt lgkmcnt(0)
s_mov_b64 s[74:75], exec
s_mov_b64 exec, 1
ds_add_u32 v7, v6 offset:4
s_mov_b64 exec, s[74:75]
v_bfe_u32 v3, v1, 3, 1
v_lshlrev_b32 v3, 8, v3
v_lshrrev_b32 v4, 4, v1
v_lshlrev_b32 v4, 6, v4
v_add_u32 v3, v3, v4
v_and_b32 v4, 3, v1
v_lshlrev_b32 v4, 4, v4
v_add_u32 v3, v3, v4
v_lshrrev_b32 v120, 5, v1
v_lshlrev_b32 v120, 9, v120
v_and_b32 v4, 15, v1
v_lshlrev_b32 v4, 5, v4
v_add_u32 v120, v120, v4
v_bfe_u32 v4, v1, 4, 1
v_lshlrev_b32 v4, 4, v4
v_add_u32 v120, v120, v4
s_lshl_b32 s72, s95, 10
v_add_u32 v120, s72, v120
v_and_b32 v121, 8, v1
s_lshl_b32 s72, s95, 4
v_add_u32 v121, s72, v121
v_bfe_u32 v4, v1, 2, 1
v_cmp_eq_u32 s[76:77], 0, v4
s_lshl_b32 s72, s92, 14
s_lshl_b32 s73, s93, 9
s_add_u32 s80, s72, s73
s_add_u32 s80, s80, 458752
s_add_u32 s81, s80, 4194304
s_lshl_b32 s72, s92, 8
s_and_b32 s73, s93, 7
s_lshl_b32 s73, s73, 4
s_add_u32 s72, s72, s73
s_lshr_b32 s73, s93, 3
s_lshl_b32 s73, s73, 3
s_add_u32 s82, s72, s73
s_add_u32 s82, s82, 425984
s_add_u32 s83, s82, 4194304
v_mov_b32 v7, 0
s_mov_b32 s73, 400000
LW_27:
ds_read_b32 v6, v7 offset:8
s_waitcnt lgkmcnt(0)
v_readfirstlane_b32 s72, v6
s_cmp_ge_u32 s72, 1
s_cbranch_scc1 LWE_28
s_sub_u32 s73, s73, 1
s_cmp_eq_u32 s73, 0
s_cbranch_scc1 LWE_28
s_sleep 1
s_branch LW_27
LWE_28:
s_setprio 2
ds_read_b128 v[76:79], v3 offset:1280
s_waitcnt lgkmcnt(0)
v_cndmask_b32 v72, 0, v76, s[76:77]
v_cndmask_b32 v73, 0, v77, s[76:77]
v_cndmask_b32 v74, 0, v78, s[76:77]
v_cndmask_b32 v75, 0, v79, s[76:77]
v_cndmask_b32 v76, v76, 0, s[76:77]
v_cndmask_b32 v77, v77, 0, s[76:77]
v_cndmask_b32 v78, v78, 0, s[76:77]
v_cndmask_b32 v79, v79, 0, s[76:77]
s_nop 0
s_waitcnt vmcnt(14)
v_mfma_f32_16x16x32_bf16 v[80:83], v[8:11], v[72:75], 0
v_mfma_f32_16x16x32_bf16 v[80:83], v[12:15], v[76:79], v[80:83]
s_waitcnt vmcnt(12)
v_mfma_f32_16x16x32_bf16 v[84:87], v[16:19], v[72:75], 0
v_mfma_f32_16x16x32_bf16 v[84:87], v[20:23], v[76:79], v[84:87]
s_waitcnt vmcnt(10)
v_mfma_f32_16x16x32_bf16 v[88:91], v[24:27], v[72:75], 0
v_mfma_f32_16x16x32_bf16 v[88:91], v[28:31], v[76:79], v[88:91]
s_waitcnt vmcnt(8)
v_mfma_f32_16x16x32_bf16 v[92:95], v[32:35], v[72:75], 0
v_mfma_f32_16x16x32_bf16 v[92:95], v[36:39], v[76:79], v[92:95]
s_nop 4
v_mov_b32_dpp v96, v80 quad_perm:[0,0,0,0] row_mask:0xf bank_mask:0xf
v_mov_b32_dpp v97, v84 quad_perm:[0,0,0,0] row_mask:0xf bank_mask:0xf
v_mov_b32_dpp v98, v88 quad_perm:[0,0,0,0] row_mask:0xf bank_mask:0xf
s_nop 2
v_mov_b32_dpp v99, v92 quad_perm:[0,0,0,0] row_mask:0xf bank_mask:0xf
v_add_f32_dpp v96, v81, v96 quad_perm:[1,1,1,1] row_mask:0xf bank_mask:0xf
v_add_f32_dpp v97, v85, v97 quad_perm:[1,1,1,1] row_mask:0xf bank_mask:0xf
v_add_f32_dpp v98, v89, v98 quad_perm:[1,1,1,1] row_mask:0xf bank_mask:0xf
v_add_f32_dpp v99, v93, v99 quad_perm:[1,1,1,1] row_mask:0xf bank_mask:0xf
v_add_f32_dpp v96, v82, v96 quad_perm:[2,2,2,2] row_mask:0xf bank_mask:0xf
v_add_f32_dpp v97, v86, v97 quad_perm:[2,2,2,2] row_mask:0xf bank_mask:0xf
v_add_f32_dpp v98, v90, v98 quad_perm:[2,2,2,2] row_mask:0xf bank_mask:0xf
v_add_f32_dpp v99, v94, v99 quad_perm:[2,2,2,2] row_mask:0xf bank_mask:0xf
v_add_f32_dpp v96, v83, v96 quad_perm:[3,3,3,3] row_mask:0xf bank_mask:0xf
v_add_f32_dpp v97, v87, v97 quad_perm:[3,3,3,3] row_mask:0xf bank_mask:0xf
v_add_f32_dpp v98, v91, v98 quad_perm:[3,3,3,3] row_mask:0xf bank_mask:0xf
v_add_f32_dpp v99, v95, v99 quad_perm:[3,3,3,3] row_mask:0xf bank_mask:0xf
v_max3_f32 v116, v96, v97, v98
v_max_f32 v116, v116, v99
s_nop 1
v_max_f32_dpp v116, v116, v116 row_half_mirror row_mask:0xf bank_mask:0xf
s_nop 0
v_mov_b32 v117, v116
s_nop 1
v_permlane16_swap_b32 v116, v117
s_nop 0
v_max_f32 v116, v116, v117
v_mov_b32 v117, v116
s_nop 1
v_permlane32_swap_b32 v116, v117
s_nop 0
v_max_f32 v116, v116, v117
s_mov_b32 s72, 0x3e0293ee
v_mul_f32 v116, s72, v116
v_fma_f32 v96, v96, s72, -v116
v_fma_f32 v97, v97, s72, -v116
v_fma_f32 v98, v98, s72, -v116
v_fma_f32 v99, v99, s72, -v116
v_exp_f32 v96, v96
v_exp_f32 v97, v97
v_exp_f32 v98, v98
v_exp_f32 v99, v99
v_cvt_pk_bf16_f32 v100, v96, v96
v_cvt_pk_bf16_f32 v101, v97, v97
v_cvt_pk_bf16_f32 v102, v98, v98
v_cvt_pk_bf16_f32 v103, v99, v99
v_and_b32 v96, 0xffff0000, v100
v_and_b32 v97, 0xffff0000, v101
v_and_b32 v98, 0xffff0000, v102
v_and_b32 v99, 0xffff0000, v103
v_and_b32 v104, v100, v124
v_and_b32 v105, v100, v125
v_and_b32_dpp v106, v100, v126 row_half_mirror row_mask:0xf bank_mask:0xf
v_and_b32_dpp v107, v100, v127 row_half_mirror row_mask:0xf bank_mask:0xf
v_add_f32 v118, v96, v97
v_add_f32 v119, v98, v99
v_add_f32 v118, v118, v119
s_waitcnt vmcnt(7)
s_nop 0
v_mfma_f32_16x16x32_bf16 v[112:115], v[104:107], v[40:43], 0
v_and_b32_dpp v108, v100, v124 row_half_mirror row_mask:0xf bank_mask:0xf
v_and_b32_dpp v109, v100, v125 row_half_mirror row_mask:0xf bank_mask:0xf
v_and_b32 v110, v100, v126
v_and_b32 v111, v100, v127
v_add_f32_dpp v118, v118, v118 row_half_mirror row_mask:0xf bank_mask:0xf
s_waitcnt vmcnt(6)
s_nop 0
v_mfma_f32_16x16x32_bf16 v[112:115], v[108:111], v[44:47], v[112:115]
v_and_b32 v104, v101, v124
v_and_b32 v105, v101, v125
v_and_b32_dpp v106, v101, v126 row_half_mirror row_mask:0xf bank_mask:0xf
v_and_b32_dpp v107, v101, v127 row_half_mirror row_mask:0xf bank_mask:0xf
v_mov_b32 v117, v118
s_waitcnt vmcnt(5)
s_nop 0
v_mfma_f32_16x16x32_bf16 v[112:115], v[104:107], v[48:51], v[112:115]
v_and_b32_dpp v108, v101, v124 row_half_mirror row_mask:0xf bank_mask:0xf
v_and_b32_dpp v109, v101, v125 row_half_mirror row_mask:0xf bank_mask:0xf
v_and_b32 v110, v101, v126
v_and_b32 v111, v101, v127
v_permlane16_swap_b32 v118, v117
s_waitcnt vmcnt(4)
s_nop 0
v_mfma_f32_16x16x32_bf16 v[112:115], v[108:111], v[52:55], v[112:115]
v_and_b32 v104, v102, v124
v_and_b32 v105, v102, v125
v_and_b32_dpp v106, v102, v126 row_half_mirror row_mask:0xf bank_mask:0xf
v_and_b32_dpp v107, v102, v127 row_half_mirror row_mask:0xf bank_mask:0xf
v_add_f32 v118, v118, v117
v_mov_b32 v117, v118
s_waitcnt vmcnt(3)
s_nop 0
v_mfma_f32_16x16x32_bf16 v[112:115], v[104:107], v[56:59], v[112:115]
v_and_b32_dpp v108, v102, v124 row_half_mirror row_mask:0xf bank_mask:0xf
v_and_b32_dpp v109, v102, v125 row_half_mirror row_mask:0xf bank_mask:0xf
v_and_b32 v110, v102, v126
v_and_b32 v111, v102, v127
v_permlane32_swap_b32 v118, v117
s_waitcnt vmcnt(2)
s_nop 0
v_mfma_f32_16x16x32_bf16 v[112:115], v[108:111], v[60:63], v[112:115]
v_and_b32 v104, v103, v124
v_and_b32 v105, v103, v125
v_and_b32_dpp v106, v103, v126 row_half_mirror row_mask:0xf bank_mask:0xf
v_and_b32_dpp v107, v103, v127 row_half_mirror row_mask:0xf bank_mask:0xf
v_add_f32 v117, v118, v117
s_waitcnt vmcnt(1)
s_nop 0
v_mfma_f32_16x16x32_bf16 v[112:115], v[104:107], v[64:67], v[112:115]
v_and_b32_dpp v108, v103, v124 row_half_mirror row_mask:0xf bank_mask:0xf
v_and_b32_dpp v109, v103, v125 row_half_mirror row_mask:0xf bank_mask:0xf
v_and_b32 v110, v103, v126
v_and_b32 v111, v103, v127
s_waitcnt vmcnt(0)
s_nop 0
v_mfma_f32_16x16x32_bf16 v[112:115], v[108:111], v[68:71], v[112:115]
s_mov_b64 exec, 0x101
ds_write_b64 v121, v[116:117] offset:1792
s_mov_b64 exec, -1
v_lshlrev_b32 v3, 4, v1
v_lshrrev_b32 v4, 5, v1
v_lshlrev_b32 v122, 3, v4
v_lshlrev_b32 v5, 13, v4
v_and_b32 v123, 31, v1
v_lshlrev_b32 v123, 4, v123
v_add_u32 v5, v5, v123
v_lshlrev_b32 v123, 7, v4
ds_write_b128 v120, v[112:115] offset:12288
v_mov_b32 v7, 0
v_mov_b32 v6, 1
s_waitcnt lgkmcnt(0)
s_mov_b64 s[74:75], exec
s_mov_b64 exec, 1
ds_add_rtn_u32 v6, v7, v6 offset:12
s_waitcnt lgkmcnt(0)
v_readfirstlane_b32 s72, v6
s_mov_b64 exec, s[74:75]
s_cmp_eq_u32 s72, 7
s_cbranch_scc0 L_KV_done
s_setprio 3
ds_read_b64 v[8:9], v122 offset:1792
ds_read_b64 v[10:11], v122 offset:1808
ds_read_b64 v[12:13], v122 offset:1824
ds_read_b64 v[14:15], v122 offset:1840
ds_read_b64 v[16:17], v122 offset:1856
ds_read_b64 v[18:19], v122 offset:1872
ds_read_b64 v[20:21], v122 offset:1888
ds_read_b64 v[22:23], v122 offset:1904
ds_read_b128 v[24:27], v3 offset:12288
ds_read_b128 v[28:31], v3 offset:13312
ds_read_b128 v[32:35], v3 offset:14336
ds_read_b128 v[36:39], v3 offset:15360
ds_read_b128 v[40:43], v3 offset:16384
ds_read_b128 v[44:47], v3 offset:17408
ds_read_b128 v[48:51], v3 offset:18432
s_waitcnt lgkmcnt(7)
ds_read_b128 v[52:55], v3 offset:19456
v_max3_f32 v56, v8, v10, v12
v_max3_f32 v57, v14, v16, v18
v_max3_f32 v56, v56, v20, v22
v_max_f32 v56, v56, v57
v_sub_f32 v8, v8, v56
v_sub_f32 v10, v10, v56
v_sub_f32 v12, v12, v56
v_sub_f32 v14, v14, v56
v_sub_f32 v16, v16, v56
v_sub_f32 v18, v18, v56
v_sub_f32 v20, v20, v56
v_sub_f32 v22, v22, v56
v_exp_f32 v8, v8
v_exp_f32 v10, v10
v_exp_f32 v12, v12
v_exp_f32 v14, v14
v_exp_f32 v16, v16
v_exp_f32 v18, v18
v_exp_f32 v20, v20
v_exp_f32 v22, v22
v_mov_b32 v65, s94
v_mov_b32 v67, s94
v_mov_b32 v69, s94
v_mul_f32 v57, v8, v9
v_fma_f32 v57, v10, v11, v57
v_fma_f32 v57, v12, v13, v57
v_fma_f32 v57, v14, v15, v57
v_fma_f32 v57, v16, v17, v57
v_fma_f32 v57, v18, v19, v57
v_fma_f32 v57, v20, v21, v57
v_fma_f32 v57, v22, v23, v57
v_rcp_f32 v58, v57
v_log_f32 v59, v57
s_waitcnt lgkmcnt(0)
v_mul_f32 v60, v24, v8
v_mul_f32 v61, v25, v8
v_mul_f32 v62, v26, v8
v_mul_f32 v63, v27, v8
v_fma_f32 v60, v28, v10, v60
v_fma_f32 v61, v29, v10, v61
v_fma_f32 v62, v30, v10, v62
v_fma_f32 v63, v31, v10, v63
v_fma_f32 v60, v32, v12, v60
v_fma_f32 v61, v33, v12, v61
v_fma_f32 v62, v34, v12, v62
v_fma_f32 v63, v35, v12, v63
v_fma_f32 v60, v36, v14, v60
v_fma_f32 v61, v37, v14, v61
v_fma_f32 v62, v38, v14, v62
v_fma_f32 v63, v39, v14, v63
v_fma_f32 v60, v40, v16, v60
v_fma_f32 v61, v41, v16, v61
v_fma_f32 v62, v42, v16, v62
v_fma_f32 v63, v43, v16, v63
v_fma_f32 v60, v44, v18, v60
v_fma_f32 v61, v45, v18, v61
v_fma_f32 v62, v46, v18, v62
v_fma_f32 v63, v47, v18, v63
v_fma_f32 v60, v48, v20, v60
v_fma_f32 v61, v49, v20, v61
v_fma_f32 v62, v50, v20, v62
v_fma_f32 v63, v51, v20, v63
v_fma_f32 v60, v52, v22, v60
v_fma_f32 v61, v53, v22, v61
v_fma_f32 v62, v54, v22, v62
v_fma_f32 v63, v55, v22, v63
v_mul_f32 v60, v60, v58
v_mul_f32 v61, v61, v58
v_mul_f32 v62, v62, v58
v_mul_f32 v63, v63, v58
v_add_f32 v68, v56, v59
v_cvt_pk_bf16_f32 v64, v60, v61
v_cvt_pk_bf16_f32 v66, v62, v63
buffer_store_dwordx4 v[64:67], v5, s[96:99], s80 offen
s_mov_b32 exec_lo, 1
s_mov_b32 exec_hi, 1
buffer_store_dwordx2 v[68:69], v123, s[96:99], s82 offen
buffer_store_dwordx2 v[68:69], v123, s[96:99], s83 offen sc1
s_mov_b64 exec, -1
v_mov_b32 v7, 0
v_mov_b32 v6, 1
s_waitcnt lgkmcnt(0)
s_mov_b64 s[74:75], exec
s_mov_b64 exec, 1
ds_add_u32 v7, v6 offset:28
s_mov_b64 exec, s[74:75]
buffer_store_dwordx4 v[64:67], v5, s[96:99], s81 offen sc1
L_KV_done:
s_cmp_eq_u32 s36, 2
s_cbranch_scc1 L_h3_kv
s_cmp_eq_u32 s36, 0
s_cbranch_scc1 L_fin
s_cmp_lt_u32 s90, 4
s_cselect_b32 s72, 5, 1
s_cmp_ge_u32 s37, s72
s_cbranch_scc1 L_fin
L_h3_kv:
s_cmp_eq_u32 s36, 2
s_cbranch_scc1 L_h3_w2
s_cmp_ge_u32 s90, 4
s_cbranch_scc1 L_h3_w0
v_mov_b32 v7, 0
s_mov_b32 s73, 400000
LW_29:
ds_read_b32 v6, v7 offset:40
s_waitcnt lgkmcnt(0)
v_readfirstlane_b32 s72, v6
s_cmp_ge_u32 s72, 3
s_cbranch_scc1 LWE_30
s_sub_u32 s73, s73, 1
s_cmp_eq_u32 s73, 0
s_cbranch_scc1 LWE_30
s_sleep 1
s_branch LW_29
LWE_30:
s_branch L_h3_w0
L_h3_w2:
v_mov_b32 v7, 0
s_mov_b32 s73, 400000
LW_31:
ds_read_b32 v6, v7 offset:40
s_waitcnt lgkmcnt(0)
v_readfirstlane_b32 s72, v6
s_cmp_ge_u32 s72, 6
s_cbranch_scc1 LWE_32
s_sub_u32 s73, s73, 1
s_cmp_eq_u32 s73, 0
s_cbranch_scc1 LWE_32
s_sleep 1
s_branch LW_31
LWE_32:
L_h3_w0:
s_mov_b32 s86, s95
s_add_u32 s87, s95, 9
s_branch L_h3
L_h3_slot16:
s_cmp_eq_u32 s36, 2
s_cbranch_scc1 L_h3_v2
s_cmp_ge_u32 s90, 4
s_cbranch_scc1 L_h3_v0
v_mov_b32 v7, 0
s_mov_b32 s73, 400000
LW_33:
ds_read_b32 v6, v7 offset:40
s_waitcnt lgkmcnt(0)
v_readfirstlane_b32 s72, v6
s_cmp_ge_u32 s72, 3
s_cbranch_scc1 LWE_34
s_sub_u32 s73, s73, 1
s_cmp_eq_u32 s73, 0
s_cbranch_scc1 LWE_34
s_sleep 1
s_branch LW_33
LWE_34:
s_branch L_h3_v0
L_h3_v2:
v_mov_b32 v7, 0
s_mov_b32 s73, 400000
LW_35:
ds_read_b32 v6, v7 offset:40
s_waitcnt lgkmcnt(0)
v_readfirstlane_b32 s72, v6
s_cmp_ge_u32 s72, 6
s_cbranch_scc1 LWE_36
s_sub_u32 s73, s73, 1
s_cmp_eq_u32 s73, 0
s_cbranch_scc1 LWE_36
s_sleep 1
s_branch LW_35
LWE_36:
L_h3_v0:
s_mov_b32 s86, 8
s_mov_b32 s87, 17
L_h3:
s_setprio 3
s_mul_i32 s85, s90, 9
s_cmp_lt_u32 s90, 4
s_cselect_b32 s72, 4, 8
s_add_u32 s72, s72, s37
s_cmp_eq_u32 s36, 2
s_cselect_b32 s72, s37, s72
s_add_u32 s85, s85, s72
s_lshl_b32 s80, s86, 4
s_cmp_eq_u32 s87, 17
s_cselect_b32 s81, 8, s87
s_lshl_b32 s81, s81, 4
s_mul_i32 s80, s80, 4608
s_mul_i32 s81, s81, 4608
s_lshl_b32 s72, s85, 6
s_add_u32 s72, s72, 786432
s_add_u32 s80, s80, s72
s_add_u32 s81, s81, s72
v_lshrrev_b32 v8, 2, v1
v_mul_u32_u24 v8, 4608, v8
v_and_b32 v9, 3, v1
v_lshlrev_b32 v9, 4, v9
v_add_u32 v8, v8, v9
v_lshlrev_b32 v9, 3, v1
s_lshl_b32 s72, s86, 5
v_add_u32 v10, s72, v9
s_lshl_b32 s72, s87, 5
v_add_u32 v11, s72, v9
s_mov_b32 s32, s4
s_mov_b32 s33, s5
s_mov_b32 s34, 1152
s_mov_b32 s35, 0x20000
s_mov_b32 s28, s22
s_mov_b32 s29, s23
s_mov_b32 s30, 1152
s_mov_b32 s31, 0x20000
s_lshl_b32 s72, s85, 4
v_lshlrev_b32 v30, 1, v1
v_add_u32 v30, s72, v30
v_lshlrev_b32 v31, 2, v1
s_mov_b64 exec, 0xff
buffer_load_ushort v32, v30, s[32:35], 0 offen
s_mov_b64 exec, -1
s_mov_b32 s73, 40000
FP_37:
buffer_load_dwordx4 v[12:15], v8, s[96:99], s80 offen sc1
buffer_load_dwordx4 v[16:19], v8, s[96:99], s81 offen sc1
s_waitcnt vmcnt(0)
v_cmp_ne_u32 vcc, s94, v13
v_cmp_ne_u32 s[74:75], s94, v15
s_or_b64 vcc, vcc, s[74:75]
v_cmp_ne_u32 s[74:75], s94, v17
s_or_b64 vcc, vcc, s[74:75]
v_cmp_ne_u32 s[74:75], s94, v19
s_or_b64 vcc, vcc, s[74:75]
s_cmp_eq_u64 vcc, 0
s_cbranch_scc1 FPE_38
s_sub_u32 s73, s73, 1
s_cmp_eq_u32 s73, 0
s_cbranch_scc1 FPE_38
s_mov_b64 exec, vcc
s_branch FP_37
FPE_38:
s_mov_b64 exec, -1
s_nop 0
v_add_f32_dpp v12, v12, v12 row_ror:4 row_mask:0xf bank_mask:0xf
v_add_f32_dpp v14, v14, v14 row_ror:4 row_mask:0xf bank_mask:0xf
v_add_f32_dpp v16, v16, v16 row_ror:4 row_mask:0xf bank_mask:0xf
v_add_f32_dpp v18, v18, v18 row_ror:4 row_mask:0xf bank_mask:0xf
s_nop 0
v_add_f32_dpp v12, v12, v12 row_ror:8 row_mask:0xf bank_mask:0xf
v_add_f32_dpp v14, v14, v14 row_ror:8 row_mask:0xf bank_mask:0xf
v_add_f32_dpp v16, v16, v16 row_ror:8 row_mask:0xf bank_mask:0xf
v_add_f32_dpp v18, v18, v18 row_ror:8 row_mask:0xf bank_mask:0xf
v_mov_b32 v20, v12
v_mov_b32 v21, v14
v_mov_b32 v22, v16
v_mov_b32 v23, v18
v_permlane16_swap_b32 v12, v20
v_permlane16_swap_b32 v14, v21
v_permlane16_swap_b32 v16, v22
v_permlane16_swap_b32 v18, v23
s_nop 0
v_add_f32 v12, v12, v20
v_add_f32 v14, v14, v21
v_add_f32 v16, v16, v22
v_add_f32 v18, v18, v23
v_mov_b32 v20, v12
v_mov_b32 v21, v14
v_mov_b32 v22, v16
v_mov_b32 v23, v18
v_permlane32_swap_b32 v12, v20
v_permlane32_swap_b32 v14, v21
v_permlane32_swap_b32 v16, v22
v_permlane32_swap_b32 v18, v23
s_nop 0
v_add_f32 v12, v12, v20
v_add_f32 v14, v14, v21
v_add_f32 v16, v16, v22
v_add_f32 v18, v18, v23
v_mov_b32 v13, v14
v_mov_b32 v17, v18
s_mov_b64 exec, 0xf
ds_write_b64 v10, v[12:13] offset:2176
ds_write_b64 v11, v[16:17] offset:2176
s_mov_b64 exec, -1
v_mov_b32 v7, 0
v_mov_b32 v6, 1
s_waitcnt lgkmcnt(0)
s_mov_b64 s[74:75], exec
s_mov_b64 exec, 1
ds_add_rtn_u32 v6, v7, v6 offset:24
s_waitcnt lgkmcnt(0)
v_readfirstlane_b32 s72, v6
s_mov_b64 exec, s[74:75]
s_cmp_eq_u32 s72, 8
s_cbranch_scc0 L_fin
s_mov_b64 exec, 0xff
ds_read_b32 v12, v31 offset:2176
ds_read_b32 v13, v31 offset:2208
ds_read_b32 v14, v31 offset:2240
ds_read_b32 v15, v31 offset:2272
ds_read_b32 v16, v31 offset:2304
ds_read_b32 v17, v31 offset:2336
ds_read_b32 v18, v31 offset:2368
ds_read_b32 v19, v31 offset:2400
ds_read_b32 v20, v31 offset:2432
ds_read_b32 v21, v31 offset:2464
ds_read_b32 v22, v31 offset:2496
ds_read_b32 v23, v31 offset:2528
ds_read_b32 v24, v31 offset:2560
ds_read_b32 v25, v31 offset:2592
ds_read_b32 v26, v31 offset:2624
s_waitcnt lgkmcnt(6)
ds_read_b32 v55, v31 offset:2656
ds_read_b32 v56, v31 offset:2688
v_add_f32 v12, v12, v13
v_add_f32 v14, v14, v15
v_add_f32 v16, v16, v17
v_add_f32 v18, v18, v19
v_add_f32 v12, v12, v14
v_add_f32 v16, v16, v18
v_add_f32 v12, v12, v20
v_add_f32 v12, v12, v16
v_cvt_pk_bf16_f32 v12, v12, v12
v_and_b32 v12, 0xffff0000, v12
v_mul_f32 v13, 0xbfb8aa3b, v12
v_exp_f32 v13, v13
s_nop 0
v_add_f32 v13, 1.0, v13
v_rcp_f32 v13, v13
s_nop 0
v_mul_f32 v13, v13, v12
v_cvt_pk_bf16_f32 v13, v13, v13
v_and_b32 v13, 0xffff0000, v13
s_waitcnt lgkmcnt(0)
v_add_f32 v21, v21, v22
v_add_f32 v23, v23, v24
v_add_f32 v25, v25, v26
v_add_f32 v55, v55, v56
v_add_f32 v21, v21, v23
v_add_f32 v25, v25, v55
v_add_f32 v21, v21, v25
v_cvt_pk_bf16_f32 v21, v21, v21
v_and_b32 v21, 0xffff0000, v21
v_mul_f32 v13, v13, v21
v_cvt_pk_bf16_f32 v13, v13, v13
v_and_b32 v13, 0xffff0000, v13
v_lshlrev_b32 v32, 16, v32
v_add_f32 v13, v13, v32
v_cvt_pk_bf16_f32 v13, v13, v13
buffer_store_short v13, v30, s[28:31], 0 offen
s_cmp_lg_u32 s85, 0
s_cbranch_scc1 L_fin_x
s_mov_b64 exec, 1
v_mov_b32 v14, s94
v_mov_b32 v15, 0
buffer_store_dword v14, v15, s[96:99], 0 offen offset:0 sc1
L_fin_x:
s_mov_b64 exec, -1
L_fin:
L_end:
s_endpgm
.section .rodata,"a"
.p2align 6
.amdhsa_kernel recurrent_scan__sliding_block_cached__swiglu_ffn__decode_kernel
  .amdhsa_next_free_vgpr 128
  .amdhsa_next_free_sgpr 102
  .amdhsa_accum_offset 128
  .amdhsa_group_segment_fixed_size 0
  .amdhsa_kernarg_size 96
  .amdhsa_user_sgpr_count 2
  .amdhsa_user_sgpr_kernarg_segment_ptr 1
  .amdhsa_system_sgpr_workgroup_id_x 1
  .amdhsa_float_denorm_mode_32 3
.end_amdhsa_kernel
```
